```python
import torch

def _softmax(x, axis=-1):
    return torch.softmax(x, dim=axis)
def _gelu(x):
    return torch.nn.functional.gelu(x, approximate="tanh")
def _silu(x):
    return torch.nn.functional.silu(x)
def _sigmoid(x):
    return torch.sigmoid(x)
def _layernorm(x, axis=-1, eps=1e-5):
    m = x.mean(dim=axis, keepdim=True)
    v = x.var(dim=axis, keepdim=True, unbiased=False)
    return (x - m) / torch.sqrt(v + eps)
def _scatter_add(tgt, idx, src, axis=0):
    return tgt.clone().index_add_(axis, idx, src)
def _segment_sum(src, seg, n):
    out = torch.zeros((n,) + src.shape[1:], dtype=src.dtype)
    return out.index_add_(0, seg, src)
def _pad(x, pw):
    flat = tuple(v for pair in reversed(pw) for v in pair)
    return torch.nn.functional.pad(x, flat)

kernel_name = 'sequential_preLN__sliding_local_dilated__glu_gated_glu__prompt'

def setup_inputs():

    _w = (lambda a: (lambda t: t.to(torch.bfloat16) if t.is_floating_point() else t)(torch.as_tensor(a)))
    def _A_setup():
        B, S, D = 1, 2048, 640
        return {
            "x": _w((lambda *s: torch.randn(*s, dtype=torch.bfloat16) * 0.05)(B, S, D)),
            "wqkv": _w((lambda *s: torch.randn(*s, dtype=torch.bfloat16) * 0.05)(D, 3 * D)),
            "wo": _w((lambda *s: torch.randn(*s, dtype=torch.bfloat16) * 0.05)(D, D)),
        }
    _A_in = _A_setup()

    def _B_setup():
        B, S, D, F = 1, 2048, 640, 1536
        return {
            "x": _w((lambda *s: torch.randn(*s, dtype=torch.bfloat16) * 0.05)(B, S, D)),
            "w_gate": _w((lambda *s: torch.randn(*s, dtype=torch.bfloat16) * 0.05)(D, F)),
            "w_up": _w((lambda *s: torch.randn(*s, dtype=torch.bfloat16) * 0.05)(D, F)),
            "w_down": _w((lambda *s: torch.randn(*s, dtype=torch.bfloat16) * 0.05)(F, D)),
        }
    _B_in = _B_setup()

    return {
        "A_x": _A_in["x"],
        "A_wqkv": _A_in["wqkv"],
        "A_wo": _A_in["wo"],
        "B_x": _B_in["x"],
        "B_w_gate": _B_in["w_gate"],
        "B_w_up": _B_in["w_up"],
        "B_w_down": _B_in["w_down"],
    }

def reference(A_x, A_wqkv, A_wo, B_x, B_w_gate, B_w_up, B_w_down):
    def _A_ref(x, wqkv, wo):
        B, S, D = x.shape
        H = 32; Dh = D // H
        W, dil = 8, 2
        qkv = (lambda x, *d: x.permute(*d))((x @ wqkv).reshape(B, S, 3, H, Dh), 2, 0, 3, 1, 4)
        q, k, v = qkv[0], qkv[1], qkv[2]
        scale = Dh ** -0.5
        pos = torch.arange(S)
        off = torch.arange(W) * dil
        idx = pos[:, None] - off[None, :]
        mask = idx >= 0
        idx_c = torch.where(mask, idx, 0).reshape(-1)
        kg = k[:, :, idx_c, :].reshape(B, H, S, W, Dh)
        vg = v[:, :, idx_c, :].reshape(B, H, S, W, Dh)
        logits = torch.einsum("bhsd,bhswd->bhsw", q, kg) * scale
        logits = torch.where(mask[None, None, :, :], logits, -1e9)
        attn = _softmax(logits, axis=-1)
        o = torch.einsum("bhsw,bhswd->bhsd", attn, vg)
        return (lambda x, *d: x.permute(*d))(o, 0, 2, 1, 3).reshape(B, S, D) @ wo

    def _B_ref(x, w_gate, w_up, w_down):
        g = torch.einsum("bsd,df->bsf", x, w_gate)
        u = torch.einsum("bsd,df->bsf", x, w_up)
        h = _sigmoid(g) * u
        return torch.einsum("bsf,fd->bsd", h, w_down)

    x = A_x
    h = x + _A_ref(_layernorm(x, axis=-1), A_wqkv, A_wo)
    h2 = h + _B_ref(_layernorm(h, axis=-1), B_w_gate, B_w_up, B_w_down)
    return h2
```

```asm
; @launch grid=(256,1,1) block=(256,1,1) lds=163840
.amdgcn_target "amdgcn-amd-amdhsa--gfx950"
.text
.globl sequential_preLN__sliding_local_dilated__glu_gated_glu__prompt_kernel
.p2align 8
.type sequential_preLN__sliding_local_dilated__glu_gated_glu__prompt_kernel,@function
sequential_preLN__sliding_local_dilated__glu_gated_glu__prompt_kernel:
s_cmp_ge_u32 s2, 256
s_cbranch_scc1 L_done
s_getpc_b64 s[20:21]
s_load_dwordx16 s[40:55], s[0:1], 0
s_load_dwordx4 s[56:59], s[0:1], 64
s_lshr_b32 s22, s2, 3
s_mul_i32 s23, s22, 6554
s_lshr_b32 s23, s23, 16
s_mul_i32 s23, s23, 10
s_sub_u32 s22, s22, s23
s_lshl_b32 s22, s22, 12
v_lshlrev_b32 v3, 4, v0
v_add_u32 v3, s22, v3
global_load_dwordx4 a[252:255], v3, s[20:21]
v_lshrrev_b32 v3, 6, v0
v_and_b32 v1, 63, v0
v_readfirstlane_b32 s16, v3
v_lshlrev_b32 v2, 4, v1
s_bfe_u32 s20, s2, 0x20001
s_lshl_b32 s20, s20, 2
s_lshr_b32 s21, s2, 6
s_add_u32 s17, s20, s21
s_and_b32 s20, s2, 1
s_lshl_b32 s20, s20, 3
s_bfe_u32 s21, s2, 0x30003
s_or_b32 s18, s20, s21
s_lshl_b32 s20, s17, 7
s_bfe_u32 s21, s18, 0x20001
s_lshl_b32 s21, s21, 5
s_add_u32 s20, s20, s21
s_and_b32 s21, s18, 1
s_lshl_b32 s21, s21, 4
s_add_u32 s20, s20, s21
s_lshr_b32 s21, s18, 3
s_add_u32 s20, s20, s21
s_lshl_b32 s21, s16, 2
s_add_u32 s20, s20, s21
s_mul_i32 s20, s20, 1280
v_lshrrev_b32 v3, 5, v1
v_and_b32 v4, 31, v1
v_mul_u32_u24 v5, 2560, v3
v_lshl_add_u32 v5, v4, 4, v5
v_mov_b32 v7, 0x7ff00000
v_cmp_gt_u32 vcc, 16, v4
s_nop 1
v_cndmask_b32 v6, v7, v5, vcc
v_lshrrev_b32 v20, 4, v1
v_and_b32 v21, 15, v1
v_mul_u32_u24 v22, 52, v21
v_lshrrev_b32 v22, 8, v22
v_mul_u32_u24 v23, 5, v22
v_sub_u32 v23, v21, v23
v_mul_u32_u24 v24, 3840, v20
v_mul_u32_u24 v22, 1280, v22
v_add_u32 v24, v24, v22
v_lshl_add_u32 v24, v23, 4, v24
v_cmp_gt_u32 vcc, 15, v21
s_mul_i32 s21, s17, 153600
s_mul_i32 s22, s18, 80
v_cndmask_b32 v24, v7, v24, vcc
s_add_u32 s21, s21, s22
s_mul_i32 s22, s16, 15360
s_add_u32 s21, s21, s22
s_lshl_b32 s23, s16, 10
s_add_u32 s23, s23, 108544
s_add_u32 s22, s21, 122880
s_cmp_lt_u32 s16, 2
s_cselect_b32 s22, s22, 0x7ff00000
s_waitcnt lgkmcnt(0)
s_mov_b32 s8, s40
s_and_b32 s9, s41, 0xffff
s_mov_b32 s10, 0x280000
s_mov_b32 s11, 0x20000
buffer_load_dwordx4 v[8:11], v5, s[8:11], s20 offen
buffer_load_dwordx4 v[12:15], v5, s[8:11], s20 offen offset:512
buffer_load_dwordx4 v[16:19], v6, s[8:11], s20 offen offset:1024
s_mov_b32 s12, s42
s_and_b32 s13, s43, 0xffff
s_mov_b32 s14, 0x258000
s_mov_b32 s15, 0x20000
s_mov_b32 m0, s23
s_add_u32 s24, s21, 61440
buffer_load_dwordx4 v24, s[12:15], s21 offen lds
s_add_u32 m0, s23, 4096
s_load_dword s19, s[58:59], 0x0
buffer_load_dwordx4 v24, s[12:15], s24 offen lds
s_add_u32 m0, s23, 8192
s_mov_b32 s4, s58
s_and_b32 s5, s59, 0xffff
s_mov_b32 s6, 0x2000000
s_mov_b32 s7, 0x20000
buffer_load_dwordx4 v24, s[12:15], s22 offen lds
s_bfe_u32 s33, s18, 0x10002
s_mul_i32 s34, s17, 5
s_mul_i32 s35, s33, 3
s_add_u32 s34, s34, s35
s_and_b32 s35, s34, 3
s_lshr_b32 s36, s34, 2
s_mul_i32 s37, s36, 40
s_lshl_b32 s38, s35, 2
s_add_u32 s37, s37, s38
s_mul_i32 s38, s36, 160
s_mul_i32 s39, s35, 40
s_add_u32 s38, s38, s39
s_sub_u32 s38, s38, 2544
s_cmp_ge_u32 s36, 16
s_cselect_b32 s37, s38, s37
s_mul_i32 s26, s37, 1280
s_add_u32 s34, s34, 1
s_and_b32 s35, s34, 3
s_lshr_b32 s36, s34, 2
s_mul_i32 s37, s36, 40
s_lshl_b32 s38, s35, 2
s_add_u32 s37, s37, s38
s_mul_i32 s38, s36, 160
s_mul_i32 s39, s35, 40
s_add_u32 s38, s38, s39
s_sub_u32 s38, s38, 2544
s_cmp_ge_u32 s36, 16
s_cselect_b32 s37, s38, s37
s_mul_i32 s27, s37, 1280
s_add_u32 s34, s34, 1
s_and_b32 s35, s34, 3
s_lshr_b32 s36, s34, 2
s_mul_i32 s37, s36, 40
s_lshl_b32 s38, s35, 2
s_add_u32 s37, s37, s38
s_mul_i32 s38, s36, 160
s_mul_i32 s39, s35, 40
s_add_u32 s38, s38, s39
s_sub_u32 s38, s38, 2544
s_cmp_ge_u32 s36, 16
s_cselect_b32 s37, s38, s37
s_mul_i32 s28, s37, 1280
s_cmp_eq_u32 s33, 1
s_cselect_b32 s28, 0x7ff00000, s28
s_lshl_b32 s29, s16, 6
v_add_u32 v26, s29, v1
v_mul_u32_u24 v27, 0xccd, v26
v_lshrrev_b32 v27, 15, v27
v_mul_u32_u24 v28, 10, v27
v_sub_u32 v28, v26, v28
v_bfe_u32 v29, v27, 2, 1
v_mul_u32_u24 v29, 20, v29
v_and_b32 v30, 3, v27
v_add_u32 v29, v29, v30
v_mul_u32_u24 v29, 1280, v29
v_lshl_add_u32 v29, v28, 4, v29
v_mov_b32 v30, s26
v_mov_b32 v31, s27
v_cmp_le_u32 vcc, 8, v27
v_cmp_le_u32 s[30:31], 16, v27
v_mov_b32 v32, s28
v_cndmask_b32 v30, v30, v31, vcc
v_cmp_le_u32 vcc, 24, v27
v_cndmask_b32 v30, v30, v32, s[30:31]
v_add_u32 v29, v29, v30
s_lshr_b32 s29, s18, 3
s_lshl_b32 s29, s29, 2
s_and_b32 s30, s18, 3
s_or_b32 s29, s29, s30
s_mul_i32 s29, s29, 160
v_add_u32 v29, s29, v29
v_cndmask_b32 v72, v29, v7, vcc
s_lshl_b32 s25, s16, 10
s_add_u32 s25, s25, 69632
s_mov_b32 s12, s44
s_and_b32 s13, s45, 0xffff
s_mov_b32 s14, 0xc8000
s_mov_b32 s15, 0x20000
s_mov_b32 m0, s25
s_nop 0
buffer_load_dwordx4 v72, s[12:15], 0 offen lds
s_lshr_b32 s20, s18, 3
s_lshl_b32 s20, s20, 2
s_and_b32 s21, s18, 3
s_or_b32 s60, s20, s21
s_bfe_u32 s61, s18, 0x10002
s_lshr_b32 s62, s16, 1
s_and_b32 s63, s16, 1
s_mov_b32 s25, s2
v_lshlrev_b32 v30, 7, v4
v_lshl_add_u32 v30, v3, 4, v30
s_lshl_b32 s20, s16, 5
s_add_u32 s20, s20, 98304
v_add_u32 v64, s20, v30
v_add_u32 v31, 8192, v64
v_mov_b32 v32, 119808
v_cmp_gt_u32 vcc, 16, v4
s_lshl_b32 s20, s16, 10
s_add_u32 s20, s20, 98304
v_cndmask_b32 v65, v32, v31, vcc
v_add_u32 v66, s20, v2
v_lshrrev_b32 v20, 4, v1
v_bfe_u32 v21, v1, 2, 2
v_and_b32 v22, 3, v1
v_and_b32 v23, 1, v20
v_mul_u32_u24 v23, 80, v23
v_lshrrev_b32 v24, 1, v20
v_mul_u32_u24 v24, 40, v24
v_add_u32 v23, v23, v24
v_lshl_add_u32 v23, v22, 3, v23
v_and_b32 v24, 1, v22
v_mul_u32_u24 v24, 80, v24
v_lshrrev_b32 v25, 1, v22
v_mul_u32_u24 v25, 40, v25
v_add3_u32 v24, v24, v25, 32
v_mul_u32_u24 v25, 40, v20
v_lshlrev_b32 v26, 3, v22
v_add_u32 v25, v25, v26
v_add_u32 v25, 120, v25
v_cmp_eq_u32 s[30:31], 0, v20
v_add_u32 v27, 224, v26
v_mul_u32_u24 v26, 40, v22
v_cndmask_b32 v25, v25, v24, s[30:31]
v_add_u32 v26, 192, v26
v_cmp_gt_u32 vcc, 2, v22
s_and_b32 s35, s16, 1
s_cmp_eq_u32 s35, 1
v_cndmask_b32 v24, v27, v26, vcc
v_cmp_eq_u32 vcc, 3, v20
s_cselect_b64 s[28:29], -1, 0
s_lshr_b32 s26, s16, 1
v_cndmask_b32 v25, v25, v24, vcc
s_lshl_b32 s27, s26, 11
s_add_u32 s27, s27, 108544
v_cndmask_b32 v23, v23, v25, s[28:29]
v_lshl_add_u32 v23, v21, 8, v23
v_add_u32 v68, s27, v23
v_lshrrev_b32 v26, 3, v1
v_lshlrev_b32 v26, 8, v26
v_and_b32 v27, 7, v1
v_lshl_add_u32 v67, v27, 4, v26
s_lshl_b32 s20, s17, 3
s_lshr_b32 s27, s18, 1
s_add_u32 s20, s20, s27
s_mul_i32 s20, s20, 20480
s_and_b32 s27, s18, 1
s_lshl_b32 s27, s27, 7
s_add_u32 s20, s20, s27
s_lshl_b32 s27, s16, 11
s_add_u32 s20, s20, s27
s_add_u32 s20, s20, 0x10000
s_add_u32 s21, s20, 16384
s_cmp_lt_u32 s16, 2
s_cselect_b32 s21, s21, 0x7ff00000
v_and_b32 v27, 15, v1
v_lshrrev_b32 v28, 2, v27
v_and_b32 v29, 3, v27
v_lshl_add_u32 v28, v29, 2, v28
s_and_b64 s[28:29], s[28:29], s[30:31]
s_lshl_b32 s35, s35, 12
v_cndmask_b32 v27, v27, v28, s[28:29]
v_lshlrev_b32 v27, 4, v27
v_lshl_add_u32 v27, v20, 10, v27
v_add_u32 v69, s35, v27
s_mul_i32 s28, s17, 5
s_add_u32 s28, s28, s26
s_mul_i32 s29, s18, 163840
s_add_u32 s29, s29, 0x290000
s_lshr_b32 s30, s28, 2
s_lshl_b32 s30, s30, 13
s_and_b32 s31, s28, 3
s_lshl_b32 s31, s31, 8
s_add_u32 s30, s30, s31
s_add_u32 s22, s30, s29
s_add_u32 s28, s28, 2
s_lshr_b32 s30, s28, 2
s_lshl_b32 s30, s30, 13
s_and_b32 s31, s28, 3
s_lshl_b32 s31, s31, 8
s_add_u32 s30, s30, s31
s_add_u32 s23, s30, s29
s_add_u32 s28, s28, 2
s_lshr_b32 s30, s28, 2
s_lshl_b32 s30, s30, 13
s_and_b32 s31, s28, 3
s_lshl_b32 s31, s31, 8
s_add_u32 s30, s30, s31
s_add_u32 s24, s30, s29
s_cmp_eq_u32 s26, 0
s_cselect_b32 s24, s24, 0x7ff00000
s_bfe_u32 s33, s18, 0x10002
s_mul_i32 s34, s17, 5
s_mul_i32 s35, s33, 3
s_add_u32 s34, s34, s35
s_and_b32 s35, s34, 3
s_lshr_b32 s36, s34, 2
s_cmp_ge_u32 s36, 10
s_cselect_b32 s37, 10, 0
s_cselect_b32 s38, 5120, 0
s_sub_u32 s37, s36, s37
s_mul_i32 s37, s37, 10240
s_add_u32 s37, s37, s38
s_lshl_b32 s35, s35, 8
s_add_u32 s26, s37, s35
s_add_u32 s34, s34, 1
s_and_b32 s35, s34, 3
s_lshr_b32 s36, s34, 2
s_cmp_ge_u32 s36, 10
s_cselect_b32 s37, 10, 0
s_cselect_b32 s38, 5120, 0
s_sub_u32 s37, s36, s37
s_mul_i32 s37, s37, 10240
s_add_u32 s37, s37, s38
s_lshl_b32 s35, s35, 8
s_add_u32 s27, s37, s35
s_add_u32 s34, s34, 1
s_and_b32 s35, s34, 3
s_lshr_b32 s36, s34, 2
s_cmp_ge_u32 s36, 10
s_cselect_b32 s37, 10, 0
s_cselect_b32 s38, 5120, 0
s_sub_u32 s37, s36, s37
s_mul_i32 s37, s37, 10240
s_add_u32 s37, s37, s38
s_lshl_b32 s35, s35, 8
s_add_u32 s28, s37, s35
s_cmp_eq_u32 s33, 1
s_cselect_b32 s28, 0x7ff00000, s28
v_lshrrev_b32 v20, 4, v1
s_lshl_b32 s33, s16, 2
v_add_u32 v21, s33, v20
v_mul_u32_u24 v22, 52, v21
v_lshrrev_b32 v22, 8, v22
v_mul_u32_u24 v23, 5, v22
v_sub_u32 v23, v21, v23
v_bfe_u32 v24, v1, 2, 2
v_and_b32 v25, 3, v1
v_lshl_add_u32 v26, v22, 3, v24
v_mul_u32_u24 v26, 160, v26
v_lshl_add_u32 v26, v23, 5, v26
v_lshl_add_u32 v26, v25, 3, v26
v_add_u32 v73, 69632, v26
v_mov_b32 v26, s26
v_mov_b32 v27, s27
v_cmp_le_u32 vcc, 1, v22
v_cmp_le_u32 s[34:35], 2, v22
v_mov_b32 v28, s28
v_cndmask_b32 v26, v26, v27, vcc
v_cmp_le_u32 vcc, 15, v21
v_cndmask_b32 v26, v26, v28, s[34:35]
v_and_b32 v27, 15, v1
v_lshlrev_b32 v27, 4, v27
v_lshl_add_u32 v27, v23, 10, v27
v_add_u32 v26, v26, v27
s_mul_i32 s33, s60, 102400
s_add_u32 s33, s33, 0x790000
v_add_u32 v26, s33, v26
v_cndmask_b32 v74, v26, v7, vcc
v_mov_b32 v26, 0x3f803f80
v_mov_b32 v27, 0
v_mov_b32 v28, 0
s_mov_b32 s38, 0x3acccccd
s_waitcnt vmcnt(4)
v_dot2c_f32_bf16 v27, v8, v26
v_dot2c_f32_bf16 v28, v8, v8
v_dot2c_f32_bf16 v27, v9, v26
v_dot2c_f32_bf16 v28, v9, v9
v_dot2c_f32_bf16 v27, v10, v26
v_dot2c_f32_bf16 v28, v10, v10
v_dot2c_f32_bf16 v27, v11, v26
v_dot2c_f32_bf16 v28, v11, v11
v_dot2c_f32_bf16 v27, v12, v26
v_dot2c_f32_bf16 v28, v12, v12
v_dot2c_f32_bf16 v27, v13, v26
v_dot2c_f32_bf16 v28, v13, v13
v_dot2c_f32_bf16 v27, v14, v26
v_dot2c_f32_bf16 v28, v14, v14
v_dot2c_f32_bf16 v27, v15, v26
v_dot2c_f32_bf16 v28, v15, v15
v_dot2c_f32_bf16 v27, v16, v26
v_dot2c_f32_bf16 v28, v16, v16
v_dot2c_f32_bf16 v27, v17, v26
v_dot2c_f32_bf16 v28, v17, v17
v_dot2c_f32_bf16 v27, v18, v26
v_dot2c_f32_bf16 v28, v18, v18
v_dot2c_f32_bf16 v27, v19, v26
v_dot2c_f32_bf16 v28, v19, v19
s_nop 1
v_add_f32_dpp v27, v27, v27 row_ror:8 row_mask:0xf bank_mask:0xf
v_add_f32_dpp v28, v28, v28 row_ror:8 row_mask:0xf bank_mask:0xf
s_nop 0
v_add_f32_dpp v27, v27, v27 row_ror:4 row_mask:0xf bank_mask:0xf
v_add_f32_dpp v28, v28, v28 row_ror:4 row_mask:0xf bank_mask:0xf
s_nop 0
v_add_f32_dpp v27, v27, v27 row_ror:2 row_mask:0xf bank_mask:0xf
v_add_f32_dpp v28, v28, v28 row_ror:2 row_mask:0xf bank_mask:0xf
s_nop 0
v_add_f32_dpp v27, v27, v27 row_ror:1 row_mask:0xf bank_mask:0xf
v_add_f32_dpp v28, v28, v28 row_ror:1 row_mask:0xf bank_mask:0xf
v_mov_b32 v30, v27
v_mov_b32 v31, v28
s_nop 0
v_permlane16_swap_b32 v27, v30
v_permlane16_swap_b32 v28, v31
v_add_f32 v27, v27, v30
v_add_f32 v28, v28, v31
v_mul_f32 v27, s38, v27
v_mul_f32 v28, s38, v28
v_fma_f32 v28, -v27, v27, v28
v_max_f32 v28, 0, v28
v_cvt_pk_bf16_f32 v31, v27, v27
v_cvt_pk_bf16_f32 v29, v28, v28
v_and_b32 v28, 0xffff0000, v29
v_and_b32 v30, 0xffff0000, v31
v_add_f32 v28, 0x3727c5ac, v28
v_cvt_pk_bf16_f32 v29, v28, v28
v_and_b32 v28, 0xffff0000, v29
v_sqrt_f32 v28, v28
s_nop 0
v_cvt_pk_bf16_f32 v29, v28, v28
v_and_b32 v28, 0xffff0000, v29
v_rcp_f32 v28, v28
v_lshlrev_b32 v32, 16, v8
v_lshlrev_b32 v34, 16, v9
v_and_b32 v33, 0xffff0000, v8
v_and_b32 v35, 0xffff0000, v9
v_pk_add_f32 v[32:33], v[32:33], v[30:31] op_sel_hi:[1,0] neg_lo:[0,1] neg_hi:[0,1]
v_pk_add_f32 v[34:35], v[34:35], v[30:31] op_sel_hi:[1,0] neg_lo:[0,1] neg_hi:[0,1]
v_cvt_pk_bf16_f32 v8, v32, v33
v_cvt_pk_bf16_f32 v9, v34, v35
v_lshlrev_b32 v32, 16, v8
v_lshlrev_b32 v34, 16, v9
v_and_b32 v33, 0xffff0000, v8
v_and_b32 v35, 0xffff0000, v9
v_pk_mul_f32 v[32:33], v[32:33], v[28:29] op_sel_hi:[1,0]
v_pk_mul_f32 v[34:35], v[34:35], v[28:29] op_sel_hi:[1,0]
v_cvt_pk_bf16_f32 v8, v32, v33
v_cvt_pk_bf16_f32 v9, v34, v35
v_lshlrev_b32 v32, 16, v10
v_lshlrev_b32 v34, 16, v11
v_and_b32 v33, 0xffff0000, v10
v_and_b32 v35, 0xffff0000, v11
v_pk_add_f32 v[32:33], v[32:33], v[30:31] op_sel_hi:[1,0] neg_lo:[0,1] neg_hi:[0,1]
v_pk_add_f32 v[34:35], v[34:35], v[30:31] op_sel_hi:[1,0] neg_lo:[0,1] neg_hi:[0,1]
v_cvt_pk_bf16_f32 v10, v32, v33
v_cvt_pk_bf16_f32 v11, v34, v35
v_lshlrev_b32 v32, 16, v10
v_lshlrev_b32 v34, 16, v11
v_and_b32 v33, 0xffff0000, v10
v_and_b32 v35, 0xffff0000, v11
v_pk_mul_f32 v[32:33], v[32:33], v[28:29] op_sel_hi:[1,0]
v_pk_mul_f32 v[34:35], v[34:35], v[28:29] op_sel_hi:[1,0]
v_cvt_pk_bf16_f32 v10, v32, v33
v_cvt_pk_bf16_f32 v11, v34, v35
v_lshlrev_b32 v32, 16, v12
v_lshlrev_b32 v34, 16, v13
v_and_b32 v33, 0xffff0000, v12
v_and_b32 v35, 0xffff0000, v13
v_pk_add_f32 v[32:33], v[32:33], v[30:31] op_sel_hi:[1,0] neg_lo:[0,1] neg_hi:[0,1]
v_pk_add_f32 v[34:35], v[34:35], v[30:31] op_sel_hi:[1,0] neg_lo:[0,1] neg_hi:[0,1]
v_cvt_pk_bf16_f32 v12, v32, v33
v_cvt_pk_bf16_f32 v13, v34, v35
v_lshlrev_b32 v32, 16, v12
v_lshlrev_b32 v34, 16, v13
v_and_b32 v33, 0xffff0000, v12
v_and_b32 v35, 0xffff0000, v13
v_pk_mul_f32 v[32:33], v[32:33], v[28:29] op_sel_hi:[1,0]
v_pk_mul_f32 v[34:35], v[34:35], v[28:29] op_sel_hi:[1,0]
v_cvt_pk_bf16_f32 v12, v32, v33
v_cvt_pk_bf16_f32 v13, v34, v35
v_lshlrev_b32 v32, 16, v14
v_lshlrev_b32 v34, 16, v15
v_and_b32 v33, 0xffff0000, v14
v_and_b32 v35, 0xffff0000, v15
v_pk_add_f32 v[32:33], v[32:33], v[30:31] op_sel_hi:[1,0] neg_lo:[0,1] neg_hi:[0,1]
v_pk_add_f32 v[34:35], v[34:35], v[30:31] op_sel_hi:[1,0] neg_lo:[0,1] neg_hi:[0,1]
v_cvt_pk_bf16_f32 v14, v32, v33
v_cvt_pk_bf16_f32 v15, v34, v35
v_lshlrev_b32 v32, 16, v14
v_lshlrev_b32 v34, 16, v15
v_and_b32 v33, 0xffff0000, v14
v_and_b32 v35, 0xffff0000, v15
v_pk_mul_f32 v[32:33], v[32:33], v[28:29] op_sel_hi:[1,0]
v_pk_mul_f32 v[34:35], v[34:35], v[28:29] op_sel_hi:[1,0]
v_cvt_pk_bf16_f32 v14, v32, v33
v_cvt_pk_bf16_f32 v15, v34, v35
v_lshlrev_b32 v32, 16, v16
v_lshlrev_b32 v34, 16, v17
v_and_b32 v33, 0xffff0000, v16
v_and_b32 v35, 0xffff0000, v17
v_pk_add_f32 v[32:33], v[32:33], v[30:31] op_sel_hi:[1,0] neg_lo:[0,1] neg_hi:[0,1]
v_pk_add_f32 v[34:35], v[34:35], v[30:31] op_sel_hi:[1,0] neg_lo:[0,1] neg_hi:[0,1]
v_cvt_pk_bf16_f32 v16, v32, v33
v_cvt_pk_bf16_f32 v17, v34, v35
v_lshlrev_b32 v32, 16, v16
v_lshlrev_b32 v34, 16, v17
v_and_b32 v33, 0xffff0000, v16
v_and_b32 v35, 0xffff0000, v17
v_pk_mul_f32 v[32:33], v[32:33], v[28:29] op_sel_hi:[1,0]
v_pk_mul_f32 v[34:35], v[34:35], v[28:29] op_sel_hi:[1,0]
v_cvt_pk_bf16_f32 v16, v32, v33
v_cvt_pk_bf16_f32 v17, v34, v35
v_lshlrev_b32 v32, 16, v18
v_lshlrev_b32 v34, 16, v19
v_and_b32 v33, 0xffff0000, v18
v_and_b32 v35, 0xffff0000, v19
v_pk_add_f32 v[32:33], v[32:33], v[30:31] op_sel_hi:[1,0] neg_lo:[0,1] neg_hi:[0,1]
v_pk_add_f32 v[34:35], v[34:35], v[30:31] op_sel_hi:[1,0] neg_lo:[0,1] neg_hi:[0,1]
v_cvt_pk_bf16_f32 v18, v32, v33
v_cvt_pk_bf16_f32 v19, v34, v35
v_lshlrev_b32 v32, 16, v18
v_lshlrev_b32 v34, 16, v19
v_and_b32 v33, 0xffff0000, v18
v_and_b32 v35, 0xffff0000, v19
v_pk_mul_f32 v[32:33], v[32:33], v[28:29] op_sel_hi:[1,0]
v_pk_mul_f32 v[34:35], v[34:35], v[28:29] op_sel_hi:[1,0]
v_cvt_pk_bf16_f32 v18, v32, v33
v_cvt_pk_bf16_f32 v19, v34, v35
ds_write_b128 v64, v[8:11]
ds_write_b128 v64, v[12:15] offset:4096
ds_write_b128 v65, v[16:19]
s_waitcnt vmcnt(0) lgkmcnt(0)
s_barrier
ds_read_b128 v[8:11], v66 offset:0
ds_read_b128 v[12:15], v66 offset:4096
ds_read_b128 v[16:19], v66 offset:8192
ds_read_b64_tr_b16 v[32:33], v68 offset:0
ds_read_b64_tr_b16 v[34:35], v68 offset:1024
ds_read_b64_tr_b16 v[36:37], v68 offset:4096
ds_read_b64_tr_b16 v[38:39], v68 offset:5120
ds_read_b64_tr_b16 v[40:41], v68 offset:8192
ds_read_b64_tr_b16 v[42:43], v68 offset:9216
ds_read_b64_tr_b16 v[44:45], v73
ds_read_b64_tr_b16 v[46:47], v73 offset:640
s_add_u32 s38, s20, 8192
s_waitcnt lgkmcnt(10)
buffer_store_dwordx4 v[8:11], v67, s[4:7], s20 offen sc1
s_waitcnt lgkmcnt(9)
buffer_store_dwordx4 v[12:15], v67, s[4:7], s38 offen sc1
s_waitcnt lgkmcnt(8)
buffer_store_dwordx4 v[16:19], v67, s[4:7], s21 offen sc1
s_waitcnt lgkmcnt(6)
buffer_store_dwordx4 v[32:35], v69, s[4:7], s22 offen sc1
s_waitcnt lgkmcnt(4)
buffer_store_dwordx4 v[36:39], v69, s[4:7], s23 offen sc1
s_waitcnt lgkmcnt(2)
buffer_store_dwordx4 v[40:43], v69, s[4:7], s24 offen sc1
s_waitcnt lgkmcnt(0)
buffer_store_dwordx4 v[44:47], v74, s[4:7], 0 offen sc1
s_add_u32 s19, s19, 0x9e3779b9
s_or_b32 s38, s18, s16
s_cmp_lg_u32 s38, 0
s_cbranch_scc1 L_noinit_1
v_lshlrev_b32 v44, 11, v1
s_lshl_b32 s38, s17, 7
s_add_u32 s38, s38, 0x3000
v_mov_b32 v45, s19
s_mov_b64 exec, 63
buffer_store_dword v45, v44, s[4:7], s38 offen sc1
s_mov_b64 exec, -1
L_noinit_1:
s_lshl_b32 s26, s17, 7
s_lshl_b32 s27, s18, 2
s_add_u32 s28, s26, s27
s_add_u32 s28, s28, 0x1000
s_lshl_b32 s27, s18, 7
s_lshl_b32 s29, s17, 2
s_add_u32 s29, s27, s29
s_add_u32 s29, s29, 0x1800
v_mov_b32 v40, s28
v_mov_b32 v41, s29
v_cmp_eq_u32 vcc, 0, v1
s_add_u32 s26, s26, 0x1000
v_lshlrev_b32 v42, 2, v1
v_cndmask_b32 v70, v41, v40, vcc
v_add_u32 v71, s26, v42
s_add_u32 s27, s27, 0x17c0
v_add_u32 v41, s27, v42
v_cmp_le_u32 vcc, 16, v1
s_max_u32 s27, s17, 1
s_sub_u32 s27, s27, 1
v_cndmask_b32 v71, v71, v41, vcc
s_lshl_b32 s27, s27, 7
s_add_u32 s27, s27, 0x101c
v_mov_b32 v41, s27
v_cmp_le_u32 vcc, 32, v1
v_add_u32 v42, 32, v41
v_cmp_eq_u32 s[28:29], 33, v1
v_cndmask_b32 v71, v71, v41, vcc
s_nop 0
v_cndmask_b32 v71, v71, v42, s[28:29]
s_xor_b32 s27, s18, 4
s_lshl_b32 s27, s27, 7
s_add_u32 s27, s27, 0x1740
v_lshlrev_b32 v42, 2, v1
v_add_u32 v41, s27, v42
v_cmp_le_u32 vcc, 48, v1
s_nop 1
v_cndmask_b32 v71, v71, v41, vcc
s_lshl_b32 s26, s16, 6
v_add_u32 v30, s26, v1
v_mul_u32_u24 v31, 205, v30
v_lshrrev_b32 v31, 14, v31
v_mul_u32_u24 v32, 80, v31
v_sub_u32 v32, v30, v32
v_lshrrev_b32 v48, 2, v31
v_and_b32 v33, 3, v31
v_mul_u32_u24 v33, 1280, v33
v_cmp_gt_u32 vcc, 8, v31
v_lshl_add_u32 v33, v32, 4, v33
s_nop 0
v_cndmask_b32 v51, v7, v33, vcc
s_lshl_b32 s26, s16, 6
s_add_u32 s26, s26, 256
v_add_u32 v30, s26, v1
v_mul_u32_u24 v31, 205, v30
v_lshrrev_b32 v31, 14, v31
v_mul_u32_u24 v32, 80, v31
v_sub_u32 v32, v30, v32
v_lshrrev_b32 v49, 2, v31
v_and_b32 v33, 3, v31
v_mul_u32_u24 v33, 1280, v33
v_cmp_gt_u32 vcc, 8, v31
v_lshl_add_u32 v33, v32, 4, v33
s_nop 0
v_cndmask_b32 v52, v7, v33, vcc
s_lshl_b32 s26, s16, 6
s_add_u32 s26, s26, 512
v_add_u32 v30, s26, v1
v_mul_u32_u24 v31, 205, v30
v_lshrrev_b32 v31, 14, v31
v_mul_u32_u24 v32, 80, v31
v_sub_u32 v32, v30, v32
v_lshrrev_b32 v50, 2, v31
v_and_b32 v33, 3, v31
v_mul_u32_u24 v33, 1280, v33
v_cmp_gt_u32 vcc, 8, v31
v_lshl_add_u32 v33, v32, 4, v33
s_nop 0
v_cndmask_b32 v53, v7, v33, vcc
v_lshrrev_b32 v30, 4, v1
v_bfe_u32 v31, v1, 2, 2
v_and_b32 v32, 3, v1
v_mul_u32_u24 v33, 1280, v31
v_lshl_add_u32 v33, v30, 5, v33
v_lshl_add_u32 v33, v32, 3, v33
s_lshl_b32 s26, s16, 7
v_add_u32 v54, s26, v33
v_lshrrev_b32 v33, 1, v30
v_lshlrev_b32 v33, 11, v33
v_lshl_add_u32 v33, v31, 8, v33
v_and_b32 v34, 1, v30
v_lshl_add_u32 v33, v34, 5, v33
v_lshl_add_u32 v33, v32, 3, v33
s_lshl_b32 s26, s16, 6
s_add_u32 s26, s26, 120832
v_add_u32 v62, s26, v33
v_and_b32 v34, 15, v1
v_mul_u32_u24 v33, 3072, v30
v_lshl_add_u32 v61, v34, 4, v33
s_lshl_b32 s26, s16, 2
v_add_u32 v31, s26, v30
v_mul_u32_u24 v32, 52, v31
v_lshrrev_b32 v55, 8, v32
v_mul_u32_u24 v32, 5, v55
v_sub_u32 v32, v31, v32
v_lshlrev_b32 v32, 10, v32
v_cmp_gt_u32 vcc, 40, v31
v_lshl_add_u32 v32, v34, 4, v32
s_nop 0
v_cndmask_b32 v58, v7, v32, vcc
s_lshl_b32 s26, s16, 2
s_add_u32 s26, s26, 16
v_add_u32 v31, s26, v30
v_mul_u32_u24 v32, 52, v31
v_lshrrev_b32 v56, 8, v32
v_mul_u32_u24 v32, 5, v56
v_sub_u32 v32, v31, v32
v_lshlrev_b32 v32, 10, v32
v_cmp_gt_u32 vcc, 40, v31
v_lshl_add_u32 v32, v34, 4, v32
s_nop 0
v_cndmask_b32 v59, v7, v32, vcc
s_lshl_b32 s26, s16, 2
s_add_u32 s26, s26, 32
v_add_u32 v31, s26, v30
v_mul_u32_u24 v32, 52, v31
v_lshrrev_b32 v57, 8, v32
v_mul_u32_u24 v32, 5, v57
v_sub_u32 v32, v31, v32
v_lshlrev_b32 v32, 10, v32
v_cmp_gt_u32 vcc, 40, v31
v_lshl_add_u32 v32, v34, 4, v32
s_nop 0
v_cndmask_b32 v60, v7, v32, vcc
s_cmp_ge_u32 s25, 192
s_cbranch_scc1 L_bshi_2
s_cmp_ge_u32 s25, 96
s_cselect_b32 s29, 1, 0
s_cselect_b32 s38, 96, 0
s_sub_u32 s38, s25, s38
s_mul_i32 s39, s38, 5462
s_lshr_b32 s39, s39, 16
s_mul_i32 s3, s39, 12
s_sub_u32 s38, s38, s3
s_mul_i32 s26, s39, 245760
s_lshl_b32 s3, s38, 8
s_add_u32 s26, s26, s3
s_mul_i32 s3, s16, 12288
s_add_u32 s26, s26, s3
s_mul_i32 s28, s29, 1536
s_lshl_b32 s3, s38, 7
s_add_u32 s28, s28, s3
s_lshl_b32 s3, s16, 5
s_add_u32 s28, s28, s3
s_lshl_b32 s28, s28, 5
s_lshl_b32 s3, s39, 2
s_add_u32 s28, s28, s3
s_add_u32 s28, s28, 0xeb8000
s_lshl_b32 s38, s38, 2
s_add_u32 s38, s38, s16
s_mul_i32 s3, s38, 21846
s_lshr_b32 s3, s3, 16
s_mul_i32 s69, s3, 3
s_sub_u32 s38, s38, s69
s_mul_i32 s3, s3, 40
s_mul_i32 s39, s39, 5
s_add_u32 s3, s3, s39
s_mul_i32 s3, s3, 6
s_lshl_b32 s38, s38, 1
s_add_u32 s3, s3, s38
s_add_u32 s3, s3, s29
s_lshl_b32 s3, s3, 10
s_add_u32 s27, s3, 0xaf8000
s_branch L_bsend_3
L_bshi_2:
s_sub_u32 s37, s25, 192
s_and_b32 s39, s37, 3
s_lshr_b32 s38, s37, 2
s_lshl_b32 s3, s38, 5
s_lshl_b32 s36, s39, 2
s_add_u32 s3, s3, s36
s_mul_i32 s26, s3, 1280
s_cmp_ge_u32 s38, 24
s_cselect_b32 s3, 24, 0
s_cselect_b32 s36, 5120, 0
s_sub_u32 s38, s38, s3
s_mul_i32 s3, s38, 21846
s_lshr_b32 s3, s3, 16
s_mul_i32 s37, s3, 3
s_sub_u32 s38, s38, s37
s_lshl_b32 s38, s38, 3
s_add_u32 s38, s38, s3
s_mul_i32 s38, s38, 10240
s_add_u32 s38, s38, s36
s_lshl_b32 s39, s39, 8
s_add_u32 s38, s38, s39
s_add_u32 s27, s38, 0x14d0000
s_sub_u32 s37, s25, 128
s_and_b32 s39, s37, 3
s_lshr_b32 s38, s37, 2
s_lshl_b32 s3, s38, 5
s_lshl_b32 s36, s39, 2
s_add_u32 s3, s3, s36
s_mul_i32 s28, s3, 1280
s_cmp_ge_u32 s38, 24
s_cselect_b32 s3, 24, 0
s_cselect_b32 s36, 5120, 0
s_sub_u32 s38, s38, s3
s_mul_i32 s3, s38, 21846
s_lshr_b32 s3, s3, 16
s_mul_i32 s37, s3, 3
s_sub_u32 s38, s38, s37
s_lshl_b32 s38, s38, 3
s_add_u32 s38, s38, s3
s_mul_i32 s38, s38, 10240
s_add_u32 s38, s38, s36
s_lshl_b32 s39, s39, 8
s_add_u32 s38, s38, s39
s_add_u32 s29, s38, 0x14d0000
s_sub_u32 s37, s25, 64
s_and_b32 s39, s37, 3
s_lshr_b32 s38, s37, 2
s_lshl_b32 s3, s38, 5
s_lshl_b32 s36, s39, 2
s_add_u32 s3, s3, s36
s_mul_i32 s30, s3, 1280
s_cmp_ge_u32 s38, 24
s_cselect_b32 s3, 24, 0
s_cselect_b32 s36, 5120, 0
s_sub_u32 s38, s38, s3
s_mul_i32 s3, s38, 21846
s_lshr_b32 s3, s3, 16
s_mul_i32 s37, s3, 3
s_sub_u32 s38, s38, s37
s_lshl_b32 s38, s38, 3
s_add_u32 s38, s38, s3
s_mul_i32 s38, s38, 10240
s_add_u32 s38, s38, s36
s_lshl_b32 s39, s39, 8
s_add_u32 s38, s38, s39
s_add_u32 s31, s38, 0x14d0000
L_bsend_3:
s_cmp_ge_u32 s25, 192
s_cbranch_scc1 L_blhi_4
s_cmp_eq_u32 s29, 1
s_cselect_b32 s12, s50, s48
s_cselect_b32 s13, s51, s49
s_and_b32 s13, s13, 0xffff
s_mov_b32 s14, 0x1e0000
s_mov_b32 s15, 0x20000
s_lshl_b32 s38, s16, 10
s_add_u32 s38, s38, 120832
s_add_u32 m0, s38, 0
s_add_u32 s39, s26, 0
buffer_load_dwordx4 v61, s[12:15], s39 offen lds
s_add_u32 m0, s38, 4096
s_add_u32 s39, s26, 49152
buffer_load_dwordx4 v61, s[12:15], s39 offen lds
s_add_u32 m0, s38, 8192
s_add_u32 s39, s26, 98304
buffer_load_dwordx4 v61, s[12:15], s39 offen lds
s_add_u32 m0, s38, 12288
s_add_u32 s39, s26, 147456
buffer_load_dwordx4 v61, s[12:15], s39 offen lds
s_add_u32 m0, s38, 16384
s_add_u32 s39, s26, 196608
buffer_load_dwordx4 v61, s[12:15], s39 offen lds
s_branch L_blend_5
L_blhi_4:
s_mov_b32 s12, s52
s_and_b32 s13, s53, 0xffff
s_mov_b32 s14, 0x1e0000
s_mov_b32 s15, 0x20000
s_mov_b32 s3, 20480
v_mad_u32_u24 v30, v48, s3, v51
v_mad_u32_u24 v31, v49, s3, v52
v_mad_u32_u24 v32, v50, s3, v53
s_lshl_b32 s38, s16, 10
s_add_u32 s38, s38, 73728
s_add_u32 m0, s38, 0
s_nop 0
buffer_load_dwordx4 v30, s[12:15], s26 offen lds
s_add_u32 m0, s38, 4096
s_nop 0
buffer_load_dwordx4 v31, s[12:15], s26 offen lds
s_add_u32 m0, s38, 8192
s_nop 0
buffer_load_dwordx4 v32, s[12:15], s26 offen lds
s_lshl_b32 s38, s16, 10
s_add_u32 s38, s38, 86016
s_add_u32 m0, s38, 0
s_nop 0
buffer_load_dwordx4 v30, s[12:15], s28 offen lds
s_add_u32 m0, s38, 4096
s_nop 0
buffer_load_dwordx4 v31, s[12:15], s28 offen lds
s_add_u32 m0, s38, 8192
s_nop 0
buffer_load_dwordx4 v32, s[12:15], s28 offen lds
s_lshl_b32 s38, s16, 10
s_add_u32 s38, s38, 120832
s_add_u32 m0, s38, 0
s_nop 0
buffer_load_dwordx4 v30, s[12:15], s30 offen lds
s_add_u32 m0, s38, 4096
s_nop 0
buffer_load_dwordx4 v31, s[12:15], s30 offen lds
s_add_u32 m0, s38, 8192
s_nop 0
buffer_load_dwordx4 v32, s[12:15], s30 offen lds
L_blend_5:
s_cmp_ge_u32 s25, 192
s_cbranch_scc1 L_drhi_6
s_waitcnt vmcnt(5)
s_branch L_drj_7
L_drhi_6:
s_waitcnt vmcnt(9)
L_drj_7:
s_barrier
s_cmp_lg_u32 s16, 0
s_cbranch_scc1 L_notw0_8
v_mov_b32 v41, s19
s_mov_b64 exec, 3
buffer_store_dword v41, v70, s[4:7], 0 offen sc1
s_mov_b64 exec, -1
L_notw0_8:
v_and_b32 v14, 15, v1
v_lshrrev_b32 v15, 4, v1
v_lshlrev_b32 v15, 2, v15
v_mov_b32 v16, 0xf149f2ca
v_mov_b32 v17, 0
s_and_b32 s50, s16, 1
s_lshr_b32 s51, s16, 1
s_or_b32 s51, s51, s50
s_or_b32 s50, s50, s17
s_cmp_lg_u32 s51, 0
s_cselect_b64 s[52:53], -1, 0
s_cmp_eq_u32 s50, 0
s_cselect_b64 s[50:51], -1, 0
v_add_u32 v18, 0, v15
v_sub_u32 v19, v14, v18
v_cmp_ge_u32 vcc, 7, v19
v_sub_u32 v20, v18, v14
v_cmp_le_i32 s[40:41], 9, v20
v_cndmask_b32 v166, v16, v17, vcc
v_cmp_le_i32 vcc, 1, v20
v_cmp_ge_u32 s[42:43], 7, v18
v_cndmask_b32 v170, v16, v17, s[40:41]
s_nop 2
s_and_b64 vcc, vcc, s[42:43]
v_cndmask_b32 v19, v16, v17, vcc
v_cndmask_b32 v19, v19, v170, s[52:53]
v_cndmask_b32 v174, v19, v16, s[50:51]
v_add_u32 v18, 1, v15
v_sub_u32 v19, v14, v18
v_cmp_ge_u32 vcc, 7, v19
v_sub_u32 v20, v18, v14
v_cmp_le_i32 s[40:41], 9, v20
v_cndmask_b32 v167, v16, v17, vcc
v_cmp_le_i32 vcc, 1, v20
v_cmp_ge_u32 s[42:43], 7, v18
v_cndmask_b32 v171, v16, v17, s[40:41]
s_nop 2
s_and_b64 vcc, vcc, s[42:43]
v_cndmask_b32 v19, v16, v17, vcc
v_cndmask_b32 v19, v19, v171, s[52:53]
v_cndmask_b32 v175, v19, v16, s[50:51]
v_add_u32 v18, 2, v15
v_sub_u32 v19, v14, v18
v_cmp_ge_u32 vcc, 7, v19
v_sub_u32 v20, v18, v14
v_cmp_le_i32 s[40:41], 9, v20
v_cndmask_b32 v168, v16, v17, vcc
v_cmp_le_i32 vcc, 1, v20
v_cmp_ge_u32 s[42:43], 7, v18
v_cndmask_b32 v172, v16, v17, s[40:41]
s_nop 2
s_and_b64 vcc, vcc, s[42:43]
v_cndmask_b32 v19, v16, v17, vcc
v_cndmask_b32 v19, v19, v172, s[52:53]
v_cndmask_b32 v176, v19, v16, s[50:51]
v_add_u32 v18, 3, v15
v_sub_u32 v19, v14, v18
v_cmp_ge_u32 vcc, 7, v19
v_sub_u32 v20, v18, v14
v_cmp_le_i32 s[40:41], 9, v20
v_cndmask_b32 v169, v16, v17, vcc
v_cmp_le_i32 vcc, 1, v20
v_cmp_ge_u32 s[42:43], 7, v18
v_cndmask_b32 v173, v16, v17, s[40:41]
s_nop 2
s_and_b64 vcc, vcc, s[42:43]
v_cndmask_b32 v19, v16, v17, vcc
v_cndmask_b32 v19, v19, v173, s[52:53]
v_cndmask_b32 v177, v19, v16, s[50:51]
v_mov_b32 v162, 0x3f803f80
v_mov_b32 v163, 0x3f803f80
v_mov_b32 v164, 0x3f803f80
v_mov_b32 v165, 0x3f803f80
s_mul_i32 s20, s18, 163840
s_lshl_b32 s23, s16, 11
s_add_u32 s20, s20, s23
s_add_u32 s20, s20, 0x290000
s_lshl_b32 s50, s17, 3
s_lshl_b32 s51, s16, 1
s_add_u32 s50, s50, s51
s_mul_i32 s50, s50, 20480
s_add_u32 s21, s50, 0x10000
s_add_u32 s50, s50, 0x510000
s_lshl_b32 s51, s18, 10
s_add_u32 s40, s50, s51
s_lshr_b32 s51, s18, 2
s_add_u32 s51, s51, 16
s_lshl_b32 s51, s51, 10
s_add_u32 s50, s50, s51
s_and_b32 s51, s18, 3
s_lshl_b32 s51, s51, 8
s_add_u32 s41, s50, s51
s_max_u32 s50, s17, 1
s_sub_u32 s50, s50, 1
s_mul_i32 s22, s50, 163840
s_lshl_b32 s51, s16, 10
s_add_u32 s22, s22, s51
s_add_u32 s22, s22, 0x10000
s_mul_i32 s24, s16, 9216
s_add_u32 s24, s24, 8192
v_and_b32 v14, 15, v1
v_or_b32 v15, 8, v1
v_lshlrev_b32 v15, 4, v15
v_mov_b32 v16, 143360
v_mov_b32 v17, 61440
v_cmp_gt_u32 vcc, 8, v14
v_add_u32 v12, 20480, v2
s_min_u32 s50, s16, 2
v_cndmask_b32 v16, v16, v17, vcc
s_lshl_b32 s51, s50, 1
s_add_u32 s51, s51, 1
v_add_u32 v13, v15, v16
s_cmp_ge_u32 s16, 2
s_cselect_b32 s51, 4, s51
s_lshl_b32 s51, s51, 10
s_add_u32 s50, s50, 5
s_lshl_b32 s50, s50, 10
v_mov_b32 v3, v2
v_add_u32 v6, s51, v3
v_add_u32 v9, s50, v3
v_add_u32 v4, 64512, v2
v_add_u32 v7, s51, v4
v_add_u32 v10, s50, v4
v_add_u32 v5, 129024, v2
v_add_u32 v8, s51, v5
v_add_u32 v11, s50, v5
s_lshl_b32 s50, s16, 12
v_add_u32 v226, s50, v2
s_sub_u32 s50, s50, 4096
s_and_b32 s51, s16, 1
s_cmp_eq_u32 s51, 1
s_cselect_b32 s50, s50, 16384
v_add_u32 v227, s50, v2
s_cmp_eq_u32 s16, 1
s_cselect_b32 s50, 1024, 0
s_cselect_b32 s51, 1028, 4
s_cselect_b32 s52, 8, 0
s_cmp_eq_u32 s16, 2
s_cselect_b32 s50, 8, s50
s_cselect_b32 s51, 1032, s51
s_cselect_b32 s52, 1024, s52
s_cselect_b64 s[42:43], -1, 0
s_cmp_eq_u32 s16, 3
s_cselect_b32 s50, 12, s50
s_cselect_b32 s51, 1036, s51
s_cselect_b32 s52, 1032, s52
s_cselect_b64 s[44:45], -1, 0
v_add_u32 v18, 16384, v2
v_add_u32 v228, s50, v18
v_add_u32 v229, s51, v18
v_add_u32 v230, s52, v18
v_lshrrev_b32 v15, 4, v1
v_lshlrev_b32 v16, 4, v14
v_lshl_add_u32 v16, v15, 3, v16
v_mov_b32 v17, 0x7ff00000
v_cmp_gt_u32 vcc, 2, v15
v_cmp_eq_u32 s[46:47], 1, v15
s_mov_b32 s48, 0x3ea52b5c
s_mov_b32 s49, s48
v_cndmask_b32 v231, v17, v16, vcc
v_mov_b32 v107, 0
v_mov_b32 v123, 0
v_mov_b32 v111, 0
v_mov_b32 v127, 0
v_mov_b32 v115, 0
v_mov_b32 v131, 0
v_mov_b32 v119, 0
v_mov_b32 v135, 0
s_lshl_b32 s50, s17, 7
s_lshl_b32 s51, s16, 5
s_add_u32 s50, s50, s51
s_add_u32 s50, s50, s61
s_mul_i32 s50, s50, 1280
s_mul_i32 s51, s60, 160
s_add_u32 s50, s50, s51
v_and_b32 v14, 15, v1
v_lshrrev_b32 v15, 4, v1
v_mul_u32_u24 v16, 2560, v14
v_lshl_add_u32 v16, v15, 3, v16
v_add_u32 v250, s50, v16
v_and_b32 v234, 15, v1
v_lshlrev_b32 v234, 7, v234
v_add_u32 v234, 0x4800, v234
s_waitcnt vmcnt(0)
s_barrier
v_lshlrev_b32 v98, 5, v1
v_cmp_gt_u32 vcc, 32, v1
v_mov_b32 v99, 0x7ff00000
s_mov_b32 s3, 245760
v_cndmask_b32 v239, v99, v98, vcc
v_mov_b32 v238, 0
v_mad_u32_u24 v251, v55, s3, v58
v_mad_u32_u24 v252, v56, s3, v59
v_mad_u32_u24 v253, v57, s3, v60
s_cmp_ge_u32 s25, 192
s_cbranch_scc1 L_bthi_10
ds_read_b64_tr_b16 a[204:205], v62 offset:0
ds_read_b64_tr_b16 a[206:207], v62 offset:1024
ds_read_b64_tr_b16 a[208:209], v62 offset:4096
ds_read_b64_tr_b16 a[210:211], v62 offset:5120
ds_read_b64_tr_b16 a[212:213], v62 offset:8192
ds_read_b64_tr_b16 a[214:215], v62 offset:9216
ds_read_b64_tr_b16 a[216:217], v62 offset:12288
ds_read_b64_tr_b16 a[218:219], v62 offset:13312
ds_read_b64_tr_b16 a[220:221], v62 offset:16384
ds_read_b64_tr_b16 a[222:223], v62 offset:17408
ds_read_b64_tr_b16 v[76:77], v62 offset:0
ds_read_b64_tr_b16 v[78:79], v62 offset:1024
ds_read_b64_tr_b16 v[80:81], v62 offset:4096
ds_read_b64_tr_b16 v[82:83], v62 offset:5120
ds_read_b64_tr_b16 v[84:85], v62 offset:8192
ds_read_b64_tr_b16 v[86:87], v62 offset:9216
ds_read_b64_tr_b16 v[88:89], v62 offset:12288
ds_read_b64_tr_b16 v[90:91], v62 offset:13312
ds_read_b64_tr_b16 v[92:93], v62 offset:16384
ds_read_b64_tr_b16 v[94:95], v62 offset:17408
v_mov_b32 v96, 0x3f803f80
v_mov_b32 v97, 0
s_waitcnt lgkmcnt(0)
v_dot2c_f32_bf16 v97, v76, v96
v_dot2c_f32_bf16 v97, v77, v96
v_dot2c_f32_bf16 v97, v78, v96
v_dot2c_f32_bf16 v97, v79, v96
v_dot2c_f32_bf16 v97, v80, v96
v_dot2c_f32_bf16 v97, v81, v96
v_dot2c_f32_bf16 v97, v82, v96
v_dot2c_f32_bf16 v97, v83, v96
v_dot2c_f32_bf16 v97, v84, v96
v_dot2c_f32_bf16 v97, v85, v96
v_dot2c_f32_bf16 v97, v86, v96
v_dot2c_f32_bf16 v97, v87, v96
v_dot2c_f32_bf16 v97, v88, v96
v_dot2c_f32_bf16 v97, v89, v96
v_dot2c_f32_bf16 v97, v90, v96
v_dot2c_f32_bf16 v97, v91, v96
v_dot2c_f32_bf16 v97, v92, v96
v_dot2c_f32_bf16 v97, v93, v96
v_dot2c_f32_bf16 v97, v94, v96
v_dot2c_f32_bf16 v97, v95, v96
s_nop 2
v_mov_b32 v98, v97
s_nop 1
v_permlane32_swap_b32 v97, v98
v_add_f32 v238, v97, v98
s_branch L_btend_11
L_bthi_10:
v_add_u32 v100, 73728, v54
ds_read_b64_tr_b16 a[204:205], v100 offset:0
ds_read_b64_tr_b16 a[206:207], v100 offset:5120
ds_read_b64_tr_b16 a[208:209], v100 offset:512
ds_read_b64_tr_b16 a[210:211], v100 offset:5632
ds_read_b64_tr_b16 a[212:213], v100 offset:1024
ds_read_b64_tr_b16 a[214:215], v100 offset:6144
v_add_u32 v100, 86016, v54
ds_read_b64_tr_b16 a[216:217], v100 offset:0
ds_read_b64_tr_b16 a[218:219], v100 offset:5120
ds_read_b64_tr_b16 a[220:221], v100 offset:512
ds_read_b64_tr_b16 a[222:223], v100 offset:5632
ds_read_b64_tr_b16 a[224:225], v100 offset:1024
ds_read_b64_tr_b16 a[226:227], v100 offset:6144
v_add_u32 v100, 120832, v54
ds_read_b64_tr_b16 a[228:229], v100 offset:0
ds_read_b64_tr_b16 a[230:231], v100 offset:5120
ds_read_b64_tr_b16 a[232:233], v100 offset:512
ds_read_b64_tr_b16 a[234:235], v100 offset:5632
ds_read_b64_tr_b16 a[236:237], v100 offset:1024
ds_read_b64_tr_b16 a[238:239], v100 offset:6144
L_btend_11:
s_waitcnt lgkmcnt(0)
s_cmp_lg_u32 s16, 0
s_cbranch_scc1 L_notw0b_9
s_mov_b32 s3, 0
L_poll_p0_12:
buffer_load_dword v42, v71, s[4:7], 0 offen sc1
s_add_u32 s3, s3, 1
s_cmp_gt_u32 s3, 400000
s_cbranch_scc1 L_polld_p0_13
s_waitcnt vmcnt(0)
v_cmp_ne_u32 vcc, s19, v42
s_nop 3
s_cmp_eq_u64 vcc, 0
s_cbranch_scc0 L_poll_p0_12
L_polld_p0_13:
s_waitcnt vmcnt(0)
L_notw0b_9:
s_barrier
s_add_u32 m0, s23, 0
s_add_u32 s37, s20, 0
buffer_load_dwordx4 v2, s[4:7], s37 offen sc1 lds
buffer_load_dwordx4 v2, s[4:7], s37 offen offset:1024 sc1 lds
s_add_u32 s38, s21, 0
buffer_load_dwordx4 a[0:3], v2, s[4:7], s38 offen offset:0 sc1
buffer_load_dwordx4 a[4:7], v12, s[4:7], s38 offen offset:0 sc1
s_add_u32 m0, s24, 0
s_add_u32 s39, s22, 0
buffer_load_dwordx4 v13, s[4:7], s39 offen sc1 lds
s_add_u32 m0, s23, 9216
s_add_u32 s37, s20, 8192
buffer_load_dwordx4 v2, s[4:7], s37 offen sc1 lds
buffer_load_dwordx4 v2, s[4:7], s37 offen offset:1024 sc1 lds
buffer_load_dwordx4 a[8:11], v2, s[4:7], s38 offen offset:1024 sc1
buffer_load_dwordx4 a[12:15], v12, s[4:7], s38 offen offset:1024 sc1
s_add_u32 m0, s23, 18432
s_add_u32 s37, s20, 16384
buffer_load_dwordx4 v2, s[4:7], s37 offen sc1 lds
buffer_load_dwordx4 v2, s[4:7], s37 offen offset:1024 sc1 lds
buffer_load_dwordx4 a[16:19], v2, s[4:7], s38 offen offset:2048 sc1
buffer_load_dwordx4 a[20:23], v12, s[4:7], s38 offen offset:2048 sc1
s_add_u32 m0, s23, 27648
s_add_u32 s37, s20, 24576
buffer_load_dwordx4 v2, s[4:7], s37 offen sc1 lds
buffer_load_dwordx4 v2, s[4:7], s37 offen offset:1024 sc1 lds
buffer_load_dwordx4 a[24:27], v2, s[4:7], s38 offen offset:3072 sc1
buffer_load_dwordx4 a[28:31], v12, s[4:7], s38 offen offset:3072 sc1
s_waitcnt vmcnt(12)
s_barrier
ds_read_b128 a[160:163], v3 offset:0
ds_read_b128 a[164:167], v3 offset:1024
ds_read_b128 a[168:171], v3 offset:2048
ds_read_b128 a[172:175], v3 offset:3072
ds_read_b128 a[176:179], v3 offset:4096
ds_read_b128 a[180:183], v3 offset:5120
ds_read_b128 a[184:187], v3 offset:6144
ds_read_b128 a[188:191], v3 offset:7168
ds_read_b128 a[192:195], v3 offset:8192
ds_read_b128 a[196:199], v6 offset:0
ds_read_b128 a[200:203], v9 offset:0
s_waitcnt vmcnt(10)
s_barrier
s_waitcnt lgkmcnt(9)
v_mfma_f32_16x16x32_bf16 v[32:35], a[160:163], a[0:3], 0
v_mfma_f32_16x16x32_bf16 v[64:67], a[160:163], a[4:7], 0
s_add_u32 m0, s23, 36864
s_add_u32 s37, s20, 32768
buffer_load_dwordx4 v2, s[4:7], s37 offen sc1 lds
v_mfma_f32_16x16x32_bf16 v[36:39], a[164:167], a[0:3], 0
ds_read_b128 a[160:163], v3 offset:9216
v_mfma_f32_16x16x32_bf16 v[68:71], a[164:167], a[4:7], 0
buffer_load_dwordx4 v2, s[4:7], s37 offen offset:1024 sc1 lds
s_waitcnt lgkmcnt(8)
v_mfma_f32_16x16x32_bf16 v[40:43], a[168:171], a[0:3], 0
ds_read_b128 a[164:167], v3 offset:10240
v_mfma_f32_16x16x32_bf16 v[72:75], a[168:171], a[4:7], 0
s_add_u32 s38, s21, 4096
buffer_load_dwordx4 a[32:35], v2, s[4:7], s38 offen offset:0 sc1
v_mfma_f32_16x16x32_bf16 v[44:47], a[172:175], a[0:3], 0
ds_read_b128 a[168:171], v3 offset:11264
v_mfma_f32_16x16x32_bf16 v[76:79], a[172:175], a[4:7], 0
buffer_load_dwordx4 a[36:39], v12, s[4:7], s38 offen offset:0 sc1
s_waitcnt lgkmcnt(8)
v_mfma_f32_16x16x32_bf16 v[48:51], a[176:179], a[0:3], 0
ds_read_b128 a[172:175], v3 offset:12288
v_mfma_f32_16x16x32_bf16 v[80:83], a[176:179], a[4:7], 0
s_add_u32 m0, s24, 36864
s_add_u32 s39, s22, 4096
buffer_load_dwordx4 v13, s[4:7], s39 offen sc1 lds
v_mfma_f32_16x16x32_bf16 v[52:55], a[0:3], a[180:183], 0
ds_read_b128 a[176:179], v3 offset:13312
v_mfma_f32_16x16x32_bf16 v[84:87], a[4:7], a[180:183], 0
s_waitcnt lgkmcnt(8)
v_mfma_f32_16x16x32_bf16 v[56:59], a[0:3], a[184:187], 0
ds_read_b128 a[180:183], v3 offset:14336
v_mfma_f32_16x16x32_bf16 v[88:91], a[4:7], a[184:187], 0
v_mfma_f32_16x16x32_bf16 v[60:63], a[0:3], a[188:191], 0
ds_read_b128 a[184:187], v3 offset:15360
v_mfma_f32_16x16x32_bf16 v[92:95], a[4:7], a[188:191], 0
s_waitcnt lgkmcnt(7)
v_mfma_f32_16x16x32_bf16 v[96:99], a[196:199], a[192:195], 0
ds_read_b128 a[188:191], v3 offset:16384
v_mfma_f32_16x16x32_bf16 v[100:103], a[192:195], a[200:203], 0
ds_read_b128 a[192:195], v3 offset:17408
ds_read_b128 a[196:199], v6 offset:9216
ds_read_b128 a[200:203], v9 offset:9216
s_waitcnt vmcnt(11)
s_barrier
s_waitcnt lgkmcnt(9)
v_mfma_f32_16x16x32_bf16 v[32:35], a[160:163], a[8:11], v[32:35]
v_mfma_f32_16x16x32_bf16 v[64:67], a[160:163], a[12:15], v[64:67]
s_add_u32 m0, s23, 46080
s_add_u32 s37, s20, 40960
buffer_load_dwordx4 v2, s[4:7], s37 offen sc1 lds
v_mfma_f32_16x16x32_bf16 v[36:39], a[164:167], a[8:11], v[36:39]
ds_read_b128 a[160:163], v3 offset:18432
v_mfma_f32_16x16x32_bf16 v[68:71], a[164:167], a[12:15], v[68:71]
buffer_load_dwordx4 v2, s[4:7], s37 offen offset:1024 sc1 lds
s_waitcnt lgkmcnt(8)
v_mfma_f32_16x16x32_bf16 v[40:43], a[168:171], a[8:11], v[40:43]
ds_read_b128 a[164:167], v3 offset:19456
v_mfma_f32_16x16x32_bf16 v[72:75], a[168:171], a[12:15], v[72:75]
buffer_load_dwordx4 a[40:43], v2, s[4:7], s38 offen offset:1024 sc1
v_mfma_f32_16x16x32_bf16 v[44:47], a[172:175], a[8:11], v[44:47]
ds_read_b128 a[168:171], v3 offset:20480
v_mfma_f32_16x16x32_bf16 v[76:79], a[172:175], a[12:15], v[76:79]
buffer_load_dwordx4 a[44:47], v12, s[4:7], s38 offen offset:1024 sc1
s_waitcnt lgkmcnt(8)
v_mfma_f32_16x16x32_bf16 v[48:51], a[176:179], a[8:11], v[48:51]
ds_read_b128 a[172:175], v3 offset:21504
v_mfma_f32_16x16x32_bf16 v[80:83], a[176:179], a[12:15], v[80:83]
v_mfma_f32_16x16x32_bf16 v[52:55], a[8:11], a[180:183], v[52:55]
ds_read_b128 a[176:179], v3 offset:22528
v_mfma_f32_16x16x32_bf16 v[84:87], a[12:15], a[180:183], v[84:87]
s_waitcnt lgkmcnt(8)
v_mfma_f32_16x16x32_bf16 v[56:59], a[8:11], a[184:187], v[56:59]
ds_read_b128 a[180:183], v3 offset:23552
v_mfma_f32_16x16x32_bf16 v[88:91], a[12:15], a[184:187], v[88:91]
v_mfma_f32_16x16x32_bf16 v[60:63], a[8:11], a[188:191], v[60:63]
ds_read_b128 a[184:187], v3 offset:24576
v_mfma_f32_16x16x32_bf16 v[92:95], a[12:15], a[188:191], v[92:95]
s_waitcnt lgkmcnt(7)
v_mfma_f32_16x16x32_bf16 v[96:99], a[196:199], a[192:195], v[96:99]
ds_read_b128 a[188:191], v3 offset:25600
v_mfma_f32_16x16x32_bf16 v[100:103], a[192:195], a[200:203], v[100:103]
ds_read_b128 a[192:195], v3 offset:26624
ds_read_b128 a[196:199], v6 offset:18432
ds_read_b128 a[200:203], v9 offset:18432
s_waitcnt vmcnt(11)
s_barrier
s_waitcnt lgkmcnt(9)
v_mfma_f32_16x16x32_bf16 v[32:35], a[160:163], a[16:19], v[32:35]
v_mfma_f32_16x16x32_bf16 v[64:67], a[160:163], a[20:23], v[64:67]
s_add_u32 m0, s23, 55296
s_add_u32 s37, s20, 49152
buffer_load_dwordx4 v2, s[4:7], s37 offen sc1 lds
v_mfma_f32_16x16x32_bf16 v[36:39], a[164:167], a[16:19], v[36:39]
ds_read_b128 a[160:163], v3 offset:27648
v_mfma_f32_16x16x32_bf16 v[68:71], a[164:167], a[20:23], v[68:71]
buffer_load_dwordx4 v2, s[4:7], s37 offen offset:1024 sc1 lds
s_waitcnt lgkmcnt(8)
v_mfma_f32_16x16x32_bf16 v[40:43], a[168:171], a[16:19], v[40:43]
ds_read_b128 a[164:167], v3 offset:28672
v_mfma_f32_16x16x32_bf16 v[72:75], a[168:171], a[20:23], v[72:75]
buffer_load_dwordx4 a[48:51], v2, s[4:7], s38 offen offset:2048 sc1
v_mfma_f32_16x16x32_bf16 v[44:47], a[172:175], a[16:19], v[44:47]
ds_read_b128 a[168:171], v3 offset:29696
v_mfma_f32_16x16x32_bf16 v[76:79], a[172:175], a[20:23], v[76:79]
buffer_load_dwordx4 a[52:55], v12, s[4:7], s38 offen offset:2048 sc1
s_waitcnt lgkmcnt(8)
v_mfma_f32_16x16x32_bf16 v[48:51], a[176:179], a[16:19], v[48:51]
ds_read_b128 a[172:175], v3 offset:30720
v_mfma_f32_16x16x32_bf16 v[80:83], a[176:179], a[20:23], v[80:83]
v_mfma_f32_16x16x32_bf16 v[52:55], a[16:19], a[180:183], v[52:55]
ds_read_b128 a[176:179], v3 offset:31744
v_mfma_f32_16x16x32_bf16 v[84:87], a[20:23], a[180:183], v[84:87]
s_waitcnt lgkmcnt(8)
v_mfma_f32_16x16x32_bf16 v[56:59], a[16:19], a[184:187], v[56:59]
ds_read_b128 a[180:183], v3 offset:32768
v_mfma_f32_16x16x32_bf16 v[88:91], a[20:23], a[184:187], v[88:91]
v_mfma_f32_16x16x32_bf16 v[60:63], a[16:19], a[188:191], v[60:63]
ds_read_b128 a[184:187], v3 offset:33792
v_mfma_f32_16x16x32_bf16 v[92:95], a[20:23], a[188:191], v[92:95]
s_waitcnt lgkmcnt(7)
v_mfma_f32_16x16x32_bf16 v[96:99], a[196:199], a[192:195], v[96:99]
ds_read_b128 a[188:191], v3 offset:34816
v_mfma_f32_16x16x32_bf16 v[100:103], a[192:195], a[200:203], v[100:103]
ds_read_b128 a[192:195], v3 offset:35840
ds_read_b128 a[196:199], v6 offset:27648
ds_read_b128 a[200:203], v9 offset:27648
s_waitcnt vmcnt(8)
s_barrier
s_waitcnt lgkmcnt(9)
v_mfma_f32_16x16x32_bf16 v[32:35], a[160:163], a[24:27], v[32:35]
v_mfma_f32_16x16x32_bf16 v[64:67], a[160:163], a[28:31], v[64:67]
s_add_u32 m0, s23, 64512
s_add_u32 s37, s20, 57344
buffer_load_dwordx4 v2, s[4:7], s37 offen sc1 lds
v_mfma_f32_16x16x32_bf16 v[36:39], a[164:167], a[24:27], v[36:39]
ds_read_b128 a[160:163], v3 offset:36864
v_mfma_f32_16x16x32_bf16 v[68:71], a[164:167], a[28:31], v[68:71]
buffer_load_dwordx4 v2, s[4:7], s37 offen offset:1024 sc1 lds
s_waitcnt lgkmcnt(8)
v_mfma_f32_16x16x32_bf16 v[40:43], a[168:171], a[24:27], v[40:43]
ds_read_b128 a[164:167], v3 offset:37888
v_mfma_f32_16x16x32_bf16 v[72:75], a[168:171], a[28:31], v[72:75]
buffer_load_dwordx4 a[56:59], v2, s[4:7], s38 offen offset:3072 sc1
v_mfma_f32_16x16x32_bf16 v[44:47], a[172:175], a[24:27], v[44:47]
ds_read_b128 a[168:171], v3 offset:38912
v_mfma_f32_16x16x32_bf16 v[76:79], a[172:175], a[28:31], v[76:79]
buffer_load_dwordx4 a[60:63], v12, s[4:7], s38 offen offset:3072 sc1
s_waitcnt lgkmcnt(8)
v_mfma_f32_16x16x32_bf16 v[48:51], a[176:179], a[24:27], v[48:51]
ds_read_b128 a[172:175], v3 offset:39936
v_mfma_f32_16x16x32_bf16 v[80:83], a[176:179], a[28:31], v[80:83]
v_mfma_f32_16x16x32_bf16 v[52:55], a[24:27], a[180:183], v[52:55]
ds_read_b128 a[176:179], v3 offset:40960
v_mfma_f32_16x16x32_bf16 v[84:87], a[28:31], a[180:183], v[84:87]
s_waitcnt lgkmcnt(8)
v_mfma_f32_16x16x32_bf16 v[56:59], a[24:27], a[184:187], v[56:59]
ds_read_b128 a[180:183], v3 offset:41984
v_mfma_f32_16x16x32_bf16 v[88:91], a[28:31], a[184:187], v[88:91]
v_mfma_f32_16x16x32_bf16 v[60:63], a[24:27], a[188:191], v[60:63]
ds_read_b128 a[184:187], v3 offset:43008
v_mfma_f32_16x16x32_bf16 v[92:95], a[28:31], a[188:191], v[92:95]
s_waitcnt lgkmcnt(7)
v_mfma_f32_16x16x32_bf16 v[96:99], a[196:199], a[192:195], v[96:99]
ds_read_b128 a[188:191], v3 offset:44032
v_mfma_f32_16x16x32_bf16 v[100:103], a[192:195], a[200:203], v[100:103]
ds_read_b128 a[192:195], v3 offset:45056
ds_read_b128 a[196:199], v6 offset:36864
ds_read_b128 a[200:203], v9 offset:36864
s_waitcnt vmcnt(10)
s_barrier
s_waitcnt lgkmcnt(9)
v_mfma_f32_16x16x32_bf16 v[32:35], a[160:163], a[32:35], v[32:35]
v_mfma_f32_16x16x32_bf16 v[64:67], a[160:163], a[36:39], v[64:67]
s_add_u32 m0, s23, 73728
s_add_u32 s37, s20, 65536
buffer_load_dwordx4 v2, s[4:7], s37 offen sc1 lds
v_mfma_f32_16x16x32_bf16 v[36:39], a[164:167], a[32:35], v[36:39]
ds_read_b128 a[160:163], v3 offset:46080
v_mfma_f32_16x16x32_bf16 v[68:71], a[164:167], a[36:39], v[68:71]
buffer_load_dwordx4 v2, s[4:7], s37 offen offset:1024 sc1 lds
s_waitcnt lgkmcnt(8)
v_mfma_f32_16x16x32_bf16 v[40:43], a[168:171], a[32:35], v[40:43]
ds_read_b128 a[164:167], v3 offset:47104
v_mfma_f32_16x16x32_bf16 v[72:75], a[168:171], a[36:39], v[72:75]
s_add_u32 s38, s21, 8192
buffer_load_dwordx4 a[64:67], v2, s[4:7], s38 offen offset:0 sc1
v_mfma_f32_16x16x32_bf16 v[44:47], a[172:175], a[32:35], v[44:47]
ds_read_b128 a[168:171], v3 offset:48128
v_mfma_f32_16x16x32_bf16 v[76:79], a[172:175], a[36:39], v[76:79]
buffer_load_dwordx4 a[68:71], v12, s[4:7], s38 offen offset:0 sc1
s_waitcnt lgkmcnt(8)
v_mfma_f32_16x16x32_bf16 v[48:51], a[176:179], a[32:35], v[48:51]
ds_read_b128 a[172:175], v3 offset:49152
v_mfma_f32_16x16x32_bf16 v[80:83], a[176:179], a[36:39], v[80:83]
s_add_u32 m0, s24, 73728
s_add_u32 s39, s22, 8192
buffer_load_dwordx4 v13, s[4:7], s39 offen sc1 lds
v_mfma_f32_16x16x32_bf16 v[52:55], a[32:35], a[180:183], v[52:55]
ds_read_b128 a[176:179], v3 offset:50176
v_mfma_f32_16x16x32_bf16 v[84:87], a[36:39], a[180:183], v[84:87]
s_waitcnt lgkmcnt(8)
v_mfma_f32_16x16x32_bf16 v[56:59], a[32:35], a[184:187], v[56:59]
ds_read_b128 a[180:183], v3 offset:51200
v_mfma_f32_16x16x32_bf16 v[88:91], a[36:39], a[184:187], v[88:91]
v_mfma_f32_16x16x32_bf16 v[60:63], a[32:35], a[188:191], v[60:63]
ds_read_b128 a[184:187], v3 offset:52224
v_mfma_f32_16x16x32_bf16 v[92:95], a[36:39], a[188:191], v[92:95]
s_waitcnt lgkmcnt(7)
v_mfma_f32_16x16x32_bf16 v[96:99], a[196:199], a[192:195], v[96:99]
ds_read_b128 a[188:191], v3 offset:53248
v_mfma_f32_16x16x32_bf16 v[100:103], a[192:195], a[200:203], v[100:103]
ds_read_b128 a[192:195], v3 offset:54272
ds_read_b128 a[196:199], v6 offset:46080
ds_read_b128 a[200:203], v9 offset:46080
s_waitcnt vmcnt(11)
s_barrier
s_waitcnt lgkmcnt(9)
v_mfma_f32_16x16x32_bf16 v[32:35], a[160:163], a[40:43], v[32:35]
v_mfma_f32_16x16x32_bf16 v[64:67], a[160:163], a[44:47], v[64:67]
s_add_u32 m0, s23, 82944
s_add_u32 s37, s20, 73728
buffer_load_dwordx4 v2, s[4:7], s37 offen sc1 lds
v_mfma_f32_16x16x32_bf16 v[36:39], a[164:167], a[40:43], v[36:39]
ds_read_b128 a[160:163], v3 offset:55296
v_mfma_f32_16x16x32_bf16 v[68:71], a[164:167], a[44:47], v[68:71]
buffer_load_dwordx4 v2, s[4:7], s37 offen offset:1024 sc1 lds
s_waitcnt lgkmcnt(8)
v_mfma_f32_16x16x32_bf16 v[40:43], a[168:171], a[40:43], v[40:43]
ds_read_b128 a[164:167], v3 offset:56320
v_mfma_f32_16x16x32_bf16 v[72:75], a[168:171], a[44:47], v[72:75]
buffer_load_dwordx4 a[72:75], v2, s[4:7], s38 offen offset:1024 sc1
v_mfma_f32_16x16x32_bf16 v[44:47], a[172:175], a[40:43], v[44:47]
ds_read_b128 a[168:171], v3 offset:57344
v_mfma_f32_16x16x32_bf16 v[76:79], a[172:175], a[44:47], v[76:79]
buffer_load_dwordx4 a[76:79], v12, s[4:7], s38 offen offset:1024 sc1
s_waitcnt lgkmcnt(8)
v_mfma_f32_16x16x32_bf16 v[48:51], a[176:179], a[40:43], v[48:51]
ds_read_b128 a[172:175], v3 offset:58368
v_mfma_f32_16x16x32_bf16 v[80:83], a[176:179], a[44:47], v[80:83]
v_mfma_f32_16x16x32_bf16 v[52:55], a[40:43], a[180:183], v[52:55]
ds_read_b128 a[176:179], v3 offset:59392
v_mfma_f32_16x16x32_bf16 v[84:87], a[44:47], a[180:183], v[84:87]
s_waitcnt lgkmcnt(8)
v_mfma_f32_16x16x32_bf16 v[56:59], a[40:43], a[184:187], v[56:59]
ds_read_b128 a[180:183], v3 offset:60416
v_mfma_f32_16x16x32_bf16 v[88:91], a[44:47], a[184:187], v[88:91]
v_mfma_f32_16x16x32_bf16 v[60:63], a[40:43], a[188:191], v[60:63]
ds_read_b128 a[184:187], v3 offset:61440
v_mfma_f32_16x16x32_bf16 v[92:95], a[44:47], a[188:191], v[92:95]
s_waitcnt lgkmcnt(7)
v_mfma_f32_16x16x32_bf16 v[96:99], a[196:199], a[192:195], v[96:99]
ds_read_b128 a[188:191], v3 offset:62464
v_mfma_f32_16x16x32_bf16 v[100:103], a[192:195], a[200:203], v[100:103]
ds_read_b128 a[192:195], v3 offset:63488
ds_read_b128 a[196:199], v6 offset:55296
ds_read_b128 a[200:203], v9 offset:55296
s_waitcnt vmcnt(11)
s_barrier
s_waitcnt lgkmcnt(9)
v_mfma_f32_16x16x32_bf16 v[32:35], a[160:163], a[48:51], v[32:35]
v_mfma_f32_16x16x32_bf16 v[64:67], a[160:163], a[52:55], v[64:67]
s_add_u32 m0, s23, 92160
s_add_u32 s37, s20, 81920
buffer_load_dwordx4 v2, s[4:7], s37 offen sc1 lds
v_mfma_f32_16x16x32_bf16 v[36:39], a[164:167], a[48:51], v[36:39]
ds_read_b128 a[160:163], v4 offset:0
v_mfma_f32_16x16x32_bf16 v[68:71], a[164:167], a[52:55], v[68:71]
buffer_load_dwordx4 v2, s[4:7], s37 offen offset:1024 sc1 lds
s_waitcnt lgkmcnt(8)
v_mfma_f32_16x16x32_bf16 v[40:43], a[168:171], a[48:51], v[40:43]
ds_read_b128 a[164:167], v4 offset:1024
v_mfma_f32_16x16x32_bf16 v[72:75], a[168:171], a[52:55], v[72:75]
buffer_load_dwordx4 a[80:83], v2, s[4:7], s38 offen offset:2048 sc1
v_mfma_f32_16x16x32_bf16 v[44:47], a[172:175], a[48:51], v[44:47]
ds_read_b128 a[168:171], v4 offset:2048
v_mfma_f32_16x16x32_bf16 v[76:79], a[172:175], a[52:55], v[76:79]
buffer_load_dwordx4 a[84:87], v12, s[4:7], s38 offen offset:2048 sc1
s_waitcnt lgkmcnt(8)
v_mfma_f32_16x16x32_bf16 v[48:51], a[176:179], a[48:51], v[48:51]
ds_read_b128 a[172:175], v4 offset:3072
v_mfma_f32_16x16x32_bf16 v[80:83], a[176:179], a[52:55], v[80:83]
v_mfma_f32_16x16x32_bf16 v[52:55], a[48:51], a[180:183], v[52:55]
ds_read_b128 a[176:179], v4 offset:4096
v_mfma_f32_16x16x32_bf16 v[84:87], a[52:55], a[180:183], v[84:87]
s_waitcnt lgkmcnt(8)
v_mfma_f32_16x16x32_bf16 v[56:59], a[48:51], a[184:187], v[56:59]
ds_read_b128 a[180:183], v4 offset:5120
v_mfma_f32_16x16x32_bf16 v[88:91], a[52:55], a[184:187], v[88:91]
v_mfma_f32_16x16x32_bf16 v[60:63], a[48:51], a[188:191], v[60:63]
ds_read_b128 a[184:187], v4 offset:6144
v_mfma_f32_16x16x32_bf16 v[92:95], a[52:55], a[188:191], v[92:95]
s_waitcnt lgkmcnt(7)
v_mfma_f32_16x16x32_bf16 v[96:99], a[196:199], a[192:195], v[96:99]
ds_read_b128 a[188:191], v4 offset:7168
v_mfma_f32_16x16x32_bf16 v[100:103], a[192:195], a[200:203], v[100:103]
ds_read_b128 a[192:195], v4 offset:8192
ds_read_b128 a[196:199], v7 offset:0
ds_read_b128 a[200:203], v10 offset:0
s_waitcnt vmcnt(8)
s_barrier
s_waitcnt lgkmcnt(9)
v_mfma_f32_16x16x32_bf16 v[32:35], a[160:163], a[56:59], v[32:35]
v_mfma_f32_16x16x32_bf16 v[64:67], a[160:163], a[60:63], v[64:67]
s_add_u32 m0, s23, 101376
s_add_u32 s37, s20, 90112
buffer_load_dwordx4 v2, s[4:7], s37 offen sc1 lds
v_mfma_f32_16x16x32_bf16 v[36:39], a[164:167], a[56:59], v[36:39]
ds_read_b128 a[160:163], v4 offset:9216
v_mfma_f32_16x16x32_bf16 v[68:71], a[164:167], a[60:63], v[68:71]
buffer_load_dwordx4 v2, s[4:7], s37 offen offset:1024 sc1 lds
s_waitcnt lgkmcnt(8)
v_mfma_f32_16x16x32_bf16 v[40:43], a[168:171], a[56:59], v[40:43]
ds_read_b128 a[164:167], v4 offset:10240
v_mfma_f32_16x16x32_bf16 v[72:75], a[168:171], a[60:63], v[72:75]
buffer_load_dwordx4 a[88:91], v2, s[4:7], s38 offen offset:3072 sc1
v_mfma_f32_16x16x32_bf16 v[44:47], a[172:175], a[56:59], v[44:47]
ds_read_b128 a[168:171], v4 offset:11264
v_mfma_f32_16x16x32_bf16 v[76:79], a[172:175], a[60:63], v[76:79]
buffer_load_dwordx4 a[92:95], v12, s[4:7], s38 offen offset:3072 sc1
s_waitcnt lgkmcnt(8)
v_mfma_f32_16x16x32_bf16 v[48:51], a[176:179], a[56:59], v[48:51]
ds_read_b128 a[172:175], v4 offset:12288
v_mfma_f32_16x16x32_bf16 v[80:83], a[176:179], a[60:63], v[80:83]
v_mfma_f32_16x16x32_bf16 v[52:55], a[56:59], a[180:183], v[52:55]
ds_read_b128 a[176:179], v4 offset:13312
v_mfma_f32_16x16x32_bf16 v[84:87], a[60:63], a[180:183], v[84:87]
s_waitcnt lgkmcnt(8)
v_mfma_f32_16x16x32_bf16 v[56:59], a[56:59], a[184:187], v[56:59]
ds_read_b128 a[180:183], v4 offset:14336
v_mfma_f32_16x16x32_bf16 v[88:91], a[60:63], a[184:187], v[88:91]
v_mfma_f32_16x16x32_bf16 v[60:63], a[56:59], a[188:191], v[60:63]
ds_read_b128 a[184:187], v4 offset:15360
v_mfma_f32_16x16x32_bf16 v[92:95], a[60:63], a[188:191], v[92:95]
s_waitcnt lgkmcnt(7)
v_mfma_f32_16x16x32_bf16 v[96:99], a[196:199], a[192:195], v[96:99]
ds_read_b128 a[188:191], v4 offset:16384
v_mfma_f32_16x16x32_bf16 v[100:103], a[192:195], a[200:203], v[100:103]
ds_read_b128 a[192:195], v4 offset:17408
ds_read_b128 a[196:199], v7 offset:9216
ds_read_b128 a[200:203], v10 offset:9216
s_waitcnt vmcnt(10)
s_barrier
s_waitcnt lgkmcnt(9)
v_mfma_f32_16x16x32_bf16 v[32:35], a[160:163], a[64:67], v[32:35]
v_mfma_f32_16x16x32_bf16 v[64:67], a[160:163], a[68:71], v[64:67]
s_add_u32 m0, s23, 110592
s_add_u32 s37, s20, 98304
buffer_load_dwordx4 v2, s[4:7], s37 offen sc1 lds
v_mfma_f32_16x16x32_bf16 v[36:39], a[164:167], a[64:67], v[36:39]
ds_read_b128 a[160:163], v4 offset:18432
v_mfma_f32_16x16x32_bf16 v[68:71], a[164:167], a[68:71], v[68:71]
buffer_load_dwordx4 v2, s[4:7], s37 offen offset:1024 sc1 lds
s_waitcnt lgkmcnt(8)
v_mfma_f32_16x16x32_bf16 v[40:43], a[168:171], a[64:67], v[40:43]
ds_read_b128 a[164:167], v4 offset:19456
v_mfma_f32_16x16x32_bf16 v[72:75], a[168:171], a[68:71], v[72:75]
s_add_u32 s38, s21, 12288
buffer_load_dwordx4 a[96:99], v2, s[4:7], s38 offen offset:0 sc1
v_mfma_f32_16x16x32_bf16 v[44:47], a[172:175], a[64:67], v[44:47]
ds_read_b128 a[168:171], v4 offset:20480
v_mfma_f32_16x16x32_bf16 v[76:79], a[172:175], a[68:71], v[76:79]
buffer_load_dwordx4 a[100:103], v12, s[4:7], s38 offen offset:0 sc1
s_waitcnt lgkmcnt(8)
v_mfma_f32_16x16x32_bf16 v[48:51], a[176:179], a[64:67], v[48:51]
ds_read_b128 a[172:175], v4 offset:21504
v_mfma_f32_16x16x32_bf16 v[80:83], a[176:179], a[68:71], v[80:83]
s_add_u32 m0, s24, 110592
s_add_u32 s39, s22, 12288
buffer_load_dwordx4 v13, s[4:7], s39 offen sc1 lds
v_mfma_f32_16x16x32_bf16 v[52:55], a[64:67], a[180:183], v[52:55]
ds_read_b128 a[176:179], v4 offset:22528
v_mfma_f32_16x16x32_bf16 v[84:87], a[68:71], a[180:183], v[84:87]
s_waitcnt lgkmcnt(8)
v_mfma_f32_16x16x32_bf16 v[56:59], a[64:67], a[184:187], v[56:59]
ds_read_b128 a[180:183], v4 offset:23552
v_mfma_f32_16x16x32_bf16 v[88:91], a[68:71], a[184:187], v[88:91]
v_mfma_f32_16x16x32_bf16 v[60:63], a[64:67], a[188:191], v[60:63]
ds_read_b128 a[184:187], v4 offset:24576
v_mfma_f32_16x16x32_bf16 v[92:95], a[68:71], a[188:191], v[92:95]
s_waitcnt lgkmcnt(7)
v_mfma_f32_16x16x32_bf16 v[96:99], a[196:199], a[192:195], v[96:99]
ds_read_b128 a[188:191], v4 offset:25600
v_mfma_f32_16x16x32_bf16 v[100:103], a[192:195], a[200:203], v[100:103]
ds_read_b128 a[192:195], v4 offset:26624
ds_read_b128 a[196:199], v7 offset:18432
ds_read_b128 a[200:203], v10 offset:18432
s_waitcnt vmcnt(11)
s_barrier
s_waitcnt lgkmcnt(9)
v_mfma_f32_16x16x32_bf16 v[32:35], a[160:163], a[72:75], v[32:35]
v_mfma_f32_16x16x32_bf16 v[64:67], a[160:163], a[76:79], v[64:67]
s_add_u32 m0, s23, 119808
s_add_u32 s37, s20, 106496
buffer_load_dwordx4 v2, s[4:7], s37 offen sc1 lds
v_mfma_f32_16x16x32_bf16 v[36:39], a[164:167], a[72:75], v[36:39]
ds_read_b128 a[160:163], v4 offset:27648
v_mfma_f32_16x16x32_bf16 v[68:71], a[164:167], a[76:79], v[68:71]
buffer_load_dwordx4 v2, s[4:7], s37 offen offset:1024 sc1 lds
s_waitcnt lgkmcnt(8)
v_mfma_f32_16x16x32_bf16 v[40:43], a[168:171], a[72:75], v[40:43]
ds_read_b128 a[164:167], v4 offset:28672
v_mfma_f32_16x16x32_bf16 v[72:75], a[168:171], a[76:79], v[72:75]
buffer_load_dwordx4 a[104:107], v2, s[4:7], s38 offen offset:1024 sc1
v_mfma_f32_16x16x32_bf16 v[44:47], a[172:175], a[72:75], v[44:47]
ds_read_b128 a[168:171], v4 offset:29696
v_mfma_f32_16x16x32_bf16 v[76:79], a[172:175], a[76:79], v[76:79]
buffer_load_dwordx4 a[108:111], v12, s[4:7], s38 offen offset:1024 sc1
s_waitcnt lgkmcnt(8)
v_mfma_f32_16x16x32_bf16 v[48:51], a[176:179], a[72:75], v[48:51]
ds_read_b128 a[172:175], v4 offset:30720
v_mfma_f32_16x16x32_bf16 v[80:83], a[176:179], a[76:79], v[80:83]
v_mfma_f32_16x16x32_bf16 v[52:55], a[72:75], a[180:183], v[52:55]
ds_read_b128 a[176:179], v4 offset:31744
v_mfma_f32_16x16x32_bf16 v[84:87], a[76:79], a[180:183], v[84:87]
s_waitcnt lgkmcnt(8)
v_mfma_f32_16x16x32_bf16 v[56:59], a[72:75], a[184:187], v[56:59]
ds_read_b128 a[180:183], v4 offset:32768
v_mfma_f32_16x16x32_bf16 v[88:91], a[76:79], a[184:187], v[88:91]
v_mfma_f32_16x16x32_bf16 v[60:63], a[72:75], a[188:191], v[60:63]
ds_read_b128 a[184:187], v4 offset:33792
v_mfma_f32_16x16x32_bf16 v[92:95], a[76:79], a[188:191], v[92:95]
s_waitcnt lgkmcnt(7)
v_mfma_f32_16x16x32_bf16 v[96:99], a[196:199], a[192:195], v[96:99]
ds_read_b128 a[188:191], v4 offset:34816
v_mfma_f32_16x16x32_bf16 v[100:103], a[192:195], a[200:203], v[100:103]
ds_read_b128 a[192:195], v4 offset:35840
ds_read_b128 a[196:199], v7 offset:27648
ds_read_b128 a[200:203], v10 offset:27648
s_waitcnt vmcnt(11)
s_barrier
s_waitcnt lgkmcnt(9)
v_mfma_f32_16x16x32_bf16 v[32:35], a[160:163], a[80:83], v[32:35]
v_mfma_f32_16x16x32_bf16 v[64:67], a[160:163], a[84:87], v[64:67]
s_add_u32 m0, s23, 129024
s_add_u32 s37, s20, 114688
buffer_load_dwordx4 v2, s[4:7], s37 offen sc1 lds
v_mfma_f32_16x16x32_bf16 v[36:39], a[164:167], a[80:83], v[36:39]
ds_read_b128 a[160:163], v4 offset:36864
v_mfma_f32_16x16x32_bf16 v[68:71], a[164:167], a[84:87], v[68:71]
buffer_load_dwordx4 v2, s[4:7], s37 offen offset:1024 sc1 lds
s_waitcnt lgkmcnt(8)
v_mfma_f32_16x16x32_bf16 v[40:43], a[168:171], a[80:83], v[40:43]
ds_read_b128 a[164:167], v4 offset:37888
v_mfma_f32_16x16x32_bf16 v[72:75], a[168:171], a[84:87], v[72:75]
buffer_load_dwordx4 a[112:115], v2, s[4:7], s38 offen offset:2048 sc1
v_mfma_f32_16x16x32_bf16 v[44:47], a[172:175], a[80:83], v[44:47]
ds_read_b128 a[168:171], v4 offset:38912
v_mfma_f32_16x16x32_bf16 v[76:79], a[172:175], a[84:87], v[76:79]
buffer_load_dwordx4 a[116:119], v12, s[4:7], s38 offen offset:2048 sc1
s_waitcnt lgkmcnt(8)
v_mfma_f32_16x16x32_bf16 v[48:51], a[176:179], a[80:83], v[48:51]
ds_read_b128 a[172:175], v4 offset:39936
v_mfma_f32_16x16x32_bf16 v[80:83], a[176:179], a[84:87], v[80:83]
v_mfma_f32_16x16x32_bf16 v[52:55], a[80:83], a[180:183], v[52:55]
ds_read_b128 a[176:179], v4 offset:40960
v_mfma_f32_16x16x32_bf16 v[84:87], a[84:87], a[180:183], v[84:87]
s_waitcnt lgkmcnt(8)
v_mfma_f32_16x16x32_bf16 v[56:59], a[80:83], a[184:187], v[56:59]
ds_read_b128 a[180:183], v4 offset:41984
v_mfma_f32_16x16x32_bf16 v[88:91], a[84:87], a[184:187], v[88:91]
v_mfma_f32_16x16x32_bf16 v[60:63], a[80:83], a[188:191], v[60:63]
ds_read_b128 a[184:187], v4 offset:43008
v_mfma_f32_16x16x32_bf16 v[92:95], a[84:87], a[188:191], v[92:95]
s_waitcnt lgkmcnt(7)
v_mfma_f32_16x16x32_bf16 v[96:99], a[196:199], a[192:195], v[96:99]
ds_read_b128 a[188:191], v4 offset:44032
v_mfma_f32_16x16x32_bf16 v[100:103], a[192:195], a[200:203], v[100:103]
ds_read_b128 a[192:195], v4 offset:45056
ds_read_b128 a[196:199], v7 offset:36864
ds_read_b128 a[200:203], v10 offset:36864
s_waitcnt vmcnt(8)
s_barrier
s_waitcnt lgkmcnt(9)
v_mfma_f32_16x16x32_bf16 v[32:35], a[160:163], a[88:91], v[32:35]
v_mfma_f32_16x16x32_bf16 v[64:67], a[160:163], a[92:95], v[64:67]
s_add_u32 m0, s23, 138240
s_add_u32 s37, s20, 122880
buffer_load_dwordx4 v2, s[4:7], s37 offen sc1 lds
v_mfma_f32_16x16x32_bf16 v[36:39], a[164:167], a[88:91], v[36:39]
ds_read_b128 a[160:163], v4 offset:46080
v_mfma_f32_16x16x32_bf16 v[68:71], a[164:167], a[92:95], v[68:71]
buffer_load_dwordx4 v2, s[4:7], s37 offen offset:1024 sc1 lds
s_waitcnt lgkmcnt(8)
v_mfma_f32_16x16x32_bf16 v[40:43], a[168:171], a[88:91], v[40:43]
ds_read_b128 a[164:167], v4 offset:47104
v_mfma_f32_16x16x32_bf16 v[72:75], a[168:171], a[92:95], v[72:75]
buffer_load_dwordx4 a[120:123], v2, s[4:7], s38 offen offset:3072 sc1
v_mfma_f32_16x16x32_bf16 v[44:47], a[172:175], a[88:91], v[44:47]
ds_read_b128 a[168:171], v4 offset:48128
v_mfma_f32_16x16x32_bf16 v[76:79], a[172:175], a[92:95], v[76:79]
buffer_load_dwordx4 a[124:127], v12, s[4:7], s38 offen offset:3072 sc1
s_waitcnt lgkmcnt(8)
v_mfma_f32_16x16x32_bf16 v[48:51], a[176:179], a[88:91], v[48:51]
ds_read_b128 a[172:175], v4 offset:49152
v_mfma_f32_16x16x32_bf16 v[80:83], a[176:179], a[92:95], v[80:83]
v_mfma_f32_16x16x32_bf16 v[52:55], a[88:91], a[180:183], v[52:55]
ds_read_b128 a[176:179], v4 offset:50176
v_mfma_f32_16x16x32_bf16 v[84:87], a[92:95], a[180:183], v[84:87]
s_waitcnt lgkmcnt(8)
v_mfma_f32_16x16x32_bf16 v[56:59], a[88:91], a[184:187], v[56:59]
ds_read_b128 a[180:183], v4 offset:51200
v_mfma_f32_16x16x32_bf16 v[88:91], a[92:95], a[184:187], v[88:91]
v_mfma_f32_16x16x32_bf16 v[60:63], a[88:91], a[188:191], v[60:63]
ds_read_b128 a[184:187], v4 offset:52224
v_mfma_f32_16x16x32_bf16 v[92:95], a[92:95], a[188:191], v[92:95]
s_waitcnt lgkmcnt(7)
v_mfma_f32_16x16x32_bf16 v[96:99], a[196:199], a[192:195], v[96:99]
ds_read_b128 a[188:191], v4 offset:53248
v_mfma_f32_16x16x32_bf16 v[100:103], a[192:195], a[200:203], v[100:103]
ds_read_b128 a[192:195], v4 offset:54272
ds_read_b128 a[196:199], v7 offset:46080
ds_read_b128 a[200:203], v10 offset:46080
s_waitcnt vmcnt(10)
s_barrier
s_waitcnt lgkmcnt(9)
v_mfma_f32_16x16x32_bf16 v[32:35], a[160:163], a[96:99], v[32:35]
v_mfma_f32_16x16x32_bf16 v[64:67], a[160:163], a[100:103], v[64:67]
s_add_u32 m0, s23, 0
s_add_u32 s37, s20, 131072
buffer_load_dwordx4 v2, s[4:7], s37 offen sc1 lds
v_mfma_f32_16x16x32_bf16 v[36:39], a[164:167], a[96:99], v[36:39]
ds_read_b128 a[160:163], v4 offset:55296
v_mfma_f32_16x16x32_bf16 v[68:71], a[164:167], a[100:103], v[68:71]
buffer_load_dwordx4 v2, s[4:7], s37 offen offset:1024 sc1 lds
s_waitcnt lgkmcnt(8)
v_mfma_f32_16x16x32_bf16 v[40:43], a[168:171], a[96:99], v[40:43]
ds_read_b128 a[164:167], v4 offset:56320
v_mfma_f32_16x16x32_bf16 v[72:75], a[168:171], a[100:103], v[72:75]
s_add_u32 s38, s21, 16384
buffer_load_dwordx4 a[128:131], v2, s[4:7], s38 offen offset:0 sc1
v_mfma_f32_16x16x32_bf16 v[44:47], a[172:175], a[96:99], v[44:47]
ds_read_b128 a[168:171], v4 offset:57344
v_mfma_f32_16x16x32_bf16 v[76:79], a[172:175], a[100:103], v[76:79]
buffer_load_dwordx4 a[132:135], v12, s[4:7], s38 offen offset:0 sc1
s_waitcnt lgkmcnt(8)
v_mfma_f32_16x16x32_bf16 v[48:51], a[176:179], a[96:99], v[48:51]
ds_read_b128 a[172:175], v4 offset:58368
v_mfma_f32_16x16x32_bf16 v[80:83], a[176:179], a[100:103], v[80:83]
s_add_u32 m0, s24, 0
s_add_u32 s39, s22, 16384
buffer_load_dwordx4 v13, s[4:7], s39 offen sc1 lds
v_mfma_f32_16x16x32_bf16 v[52:55], a[96:99], a[180:183], v[52:55]
ds_read_b128 a[176:179], v4 offset:59392
v_mfma_f32_16x16x32_bf16 v[84:87], a[100:103], a[180:183], v[84:87]
s_waitcnt lgkmcnt(8)
v_mfma_f32_16x16x32_bf16 v[56:59], a[96:99], a[184:187], v[56:59]
ds_read_b128 a[180:183], v4 offset:60416
v_mfma_f32_16x16x32_bf16 v[88:91], a[100:103], a[184:187], v[88:91]
v_mfma_f32_16x16x32_bf16 v[60:63], a[96:99], a[188:191], v[60:63]
ds_read_b128 a[184:187], v4 offset:61440
v_mfma_f32_16x16x32_bf16 v[92:95], a[100:103], a[188:191], v[92:95]
s_waitcnt lgkmcnt(7)
v_mfma_f32_16x16x32_bf16 v[96:99], a[196:199], a[192:195], v[96:99]
ds_read_b128 a[188:191], v4 offset:62464
v_mfma_f32_16x16x32_bf16 v[100:103], a[192:195], a[200:203], v[100:103]
ds_read_b128 a[192:195], v4 offset:63488
ds_read_b128 a[196:199], v7 offset:55296
ds_read_b128 a[200:203], v10 offset:55296
s_waitcnt vmcnt(11)
s_barrier
s_waitcnt lgkmcnt(9)
v_mfma_f32_16x16x32_bf16 v[32:35], a[160:163], a[104:107], v[32:35]
v_mfma_f32_16x16x32_bf16 v[64:67], a[160:163], a[108:111], v[64:67]
s_add_u32 m0, s23, 9216
s_add_u32 s37, s20, 139264
buffer_load_dwordx4 v2, s[4:7], s37 offen sc1 lds
v_mfma_f32_16x16x32_bf16 v[36:39], a[164:167], a[104:107], v[36:39]
ds_read_b128 a[160:163], v5 offset:0
v_mfma_f32_16x16x32_bf16 v[68:71], a[164:167], a[108:111], v[68:71]
buffer_load_dwordx4 v2, s[4:7], s37 offen offset:1024 sc1 lds
s_waitcnt lgkmcnt(8)
v_mfma_f32_16x16x32_bf16 v[40:43], a[168:171], a[104:107], v[40:43]
ds_read_b128 a[164:167], v5 offset:1024
v_mfma_f32_16x16x32_bf16 v[72:75], a[168:171], a[108:111], v[72:75]
buffer_load_dwordx4 a[136:139], v2, s[4:7], s38 offen offset:1024 sc1
v_mfma_f32_16x16x32_bf16 v[44:47], a[172:175], a[104:107], v[44:47]
ds_read_b128 a[168:171], v5 offset:2048
v_mfma_f32_16x16x32_bf16 v[76:79], a[172:175], a[108:111], v[76:79]
buffer_load_dwordx4 a[140:143], v12, s[4:7], s38 offen offset:1024 sc1
s_waitcnt lgkmcnt(8)
v_mfma_f32_16x16x32_bf16 v[48:51], a[176:179], a[104:107], v[48:51]
ds_read_b128 a[172:175], v5 offset:3072
v_mfma_f32_16x16x32_bf16 v[80:83], a[176:179], a[108:111], v[80:83]
v_mfma_f32_16x16x32_bf16 v[52:55], a[104:107], a[180:183], v[52:55]
ds_read_b128 a[176:179], v5 offset:4096
v_mfma_f32_16x16x32_bf16 v[84:87], a[108:111], a[180:183], v[84:87]
s_waitcnt lgkmcnt(8)
v_mfma_f32_16x16x32_bf16 v[56:59], a[104:107], a[184:187], v[56:59]
ds_read_b128 a[180:183], v5 offset:5120
v_mfma_f32_16x16x32_bf16 v[88:91], a[108:111], a[184:187], v[88:91]
v_mfma_f32_16x16x32_bf16 v[60:63], a[104:107], a[188:191], v[60:63]
ds_read_b128 a[184:187], v5 offset:6144
v_mfma_f32_16x16x32_bf16 v[92:95], a[108:111], a[188:191], v[92:95]
s_waitcnt lgkmcnt(7)
v_mfma_f32_16x16x32_bf16 v[96:99], a[196:199], a[192:195], v[96:99]
ds_read_b128 a[188:191], v5 offset:7168
v_mfma_f32_16x16x32_bf16 v[100:103], a[192:195], a[200:203], v[100:103]
ds_read_b128 a[192:195], v5 offset:8192
ds_read_b128 a[196:199], v8 offset:0
ds_read_b128 a[200:203], v11 offset:0
s_waitcnt vmcnt(11)
s_barrier
s_waitcnt lgkmcnt(9)
v_mfma_f32_16x16x32_bf16 v[32:35], a[160:163], a[112:115], v[32:35]
v_mfma_f32_16x16x32_bf16 v[64:67], a[160:163], a[116:119], v[64:67]
s_add_u32 m0, s23, 18432
s_add_u32 s37, s20, 147456
buffer_load_dwordx4 v2, s[4:7], s37 offen sc1 lds
v_mfma_f32_16x16x32_bf16 v[36:39], a[164:167], a[112:115], v[36:39]
ds_read_b128 a[160:163], v5 offset:9216
v_mfma_f32_16x16x32_bf16 v[68:71], a[164:167], a[116:119], v[68:71]
buffer_load_dwordx4 v2, s[4:7], s37 offen offset:1024 sc1 lds
s_waitcnt lgkmcnt(8)
v_mfma_f32_16x16x32_bf16 v[40:43], a[168:171], a[112:115], v[40:43]
ds_read_b128 a[164:167], v5 offset:10240
v_mfma_f32_16x16x32_bf16 v[72:75], a[168:171], a[116:119], v[72:75]
buffer_load_dwordx4 a[144:147], v2, s[4:7], s38 offen offset:2048 sc1
v_mfma_f32_16x16x32_bf16 v[44:47], a[172:175], a[112:115], v[44:47]
ds_read_b128 a[168:171], v5 offset:11264
v_mfma_f32_16x16x32_bf16 v[76:79], a[172:175], a[116:119], v[76:79]
buffer_load_dwordx4 a[148:151], v12, s[4:7], s38 offen offset:2048 sc1
s_waitcnt lgkmcnt(8)
v_mfma_f32_16x16x32_bf16 v[48:51], a[176:179], a[112:115], v[48:51]
ds_read_b128 a[172:175], v5 offset:12288
v_mfma_f32_16x16x32_bf16 v[80:83], a[176:179], a[116:119], v[80:83]
v_mfma_f32_16x16x32_bf16 v[52:55], a[112:115], a[180:183], v[52:55]
ds_read_b128 a[176:179], v5 offset:13312
v_mfma_f32_16x16x32_bf16 v[84:87], a[116:119], a[180:183], v[84:87]
s_waitcnt lgkmcnt(8)
v_mfma_f32_16x16x32_bf16 v[56:59], a[112:115], a[184:187], v[56:59]
ds_read_b128 a[180:183], v5 offset:14336
v_mfma_f32_16x16x32_bf16 v[88:91], a[116:119], a[184:187], v[88:91]
v_mfma_f32_16x16x32_bf16 v[60:63], a[112:115], a[188:191], v[60:63]
ds_read_b128 a[184:187], v5 offset:15360
v_mfma_f32_16x16x32_bf16 v[92:95], a[116:119], a[188:191], v[92:95]
s_waitcnt lgkmcnt(7)
v_mfma_f32_16x16x32_bf16 v[96:99], a[196:199], a[192:195], v[96:99]
ds_read_b128 a[188:191], v5 offset:16384
v_mfma_f32_16x16x32_bf16 v[100:103], a[192:195], a[200:203], v[100:103]
ds_read_b128 a[192:195], v5 offset:17408
ds_read_b128 a[196:199], v8 offset:9216
ds_read_b128 a[200:203], v11 offset:9216
s_waitcnt vmcnt(8)
s_barrier
s_waitcnt lgkmcnt(9)
v_mfma_f32_16x16x32_bf16 v[32:35], a[160:163], a[120:123], v[32:35]
v_mfma_f32_16x16x32_bf16 v[64:67], a[160:163], a[124:127], v[64:67]
s_add_u32 m0, s23, 27648
s_add_u32 s37, s20, 155648
buffer_load_dwordx4 v2, s[4:7], s37 offen sc1 lds
v_mfma_f32_16x16x32_bf16 v[36:39], a[164:167], a[120:123], v[36:39]
ds_read_b128 a[160:163], v3 offset:0
v_mfma_f32_16x16x32_bf16 v[68:71], a[164:167], a[124:127], v[68:71]
buffer_load_dwordx4 v2, s[4:7], s37 offen offset:1024 sc1 lds
s_waitcnt lgkmcnt(8)
v_mfma_f32_16x16x32_bf16 v[40:43], a[168:171], a[120:123], v[40:43]
ds_read_b128 a[164:167], v3 offset:1024
v_mfma_f32_16x16x32_bf16 v[72:75], a[168:171], a[124:127], v[72:75]
buffer_load_dwordx4 a[152:155], v2, s[4:7], s38 offen offset:3072 sc1
v_mfma_f32_16x16x32_bf16 v[44:47], a[172:175], a[120:123], v[44:47]
ds_read_b128 a[168:171], v3 offset:2048
v_mfma_f32_16x16x32_bf16 v[76:79], a[172:175], a[124:127], v[76:79]
buffer_load_dwordx4 a[156:159], v12, s[4:7], s38 offen offset:3072 sc1
s_waitcnt lgkmcnt(8)
v_mfma_f32_16x16x32_bf16 v[48:51], a[176:179], a[120:123], v[48:51]
ds_read_b128 a[172:175], v3 offset:3072
v_mfma_f32_16x16x32_bf16 v[80:83], a[176:179], a[124:127], v[80:83]
v_mfma_f32_16x16x32_bf16 v[52:55], a[120:123], a[180:183], v[52:55]
ds_read_b128 a[176:179], v3 offset:4096
v_mfma_f32_16x16x32_bf16 v[84:87], a[124:127], a[180:183], v[84:87]
s_waitcnt lgkmcnt(8)
v_mfma_f32_16x16x32_bf16 v[56:59], a[120:123], a[184:187], v[56:59]
ds_read_b128 a[180:183], v3 offset:5120
v_mfma_f32_16x16x32_bf16 v[88:91], a[124:127], a[184:187], v[88:91]
v_mfma_f32_16x16x32_bf16 v[60:63], a[120:123], a[188:191], v[60:63]
ds_read_b128 a[184:187], v3 offset:6144
v_mfma_f32_16x16x32_bf16 v[92:95], a[124:127], a[188:191], v[92:95]
s_waitcnt lgkmcnt(7)
v_mfma_f32_16x16x32_bf16 v[96:99], a[196:199], a[192:195], v[96:99]
ds_read_b128 a[188:191], v3 offset:7168
v_mfma_f32_16x16x32_bf16 v[100:103], a[192:195], a[200:203], v[100:103]
ds_read_b128 a[192:195], v3 offset:8192
ds_read_b128 a[196:199], v6 offset:0
ds_read_b128 a[200:203], v9 offset:0
s_waitcnt vmcnt(10)
s_barrier
s_waitcnt lgkmcnt(9)
v_mfma_f32_16x16x32_bf16 v[32:35], a[160:163], a[128:131], v[32:35]
v_mfma_f32_16x16x32_bf16 v[64:67], a[160:163], a[132:135], v[64:67]
s_cmp_ge_u32 s25, 192
s_cbranch_scc1 L_bshi_14
buffer_store_dwordx4 a[204:207], v2, s[4:7], s27 offen sc1
s_add_u32 s27, s27, 6144
buffer_store_dwordx4 a[208:211], v2, s[4:7], s27 offen sc1
s_add_u32 s27, s27, 6144
s_branch L_bsend_15
L_bshi_14:
buffer_store_dwordx4 a[204:207], v251, s[4:7], s27 offen sc1
buffer_store_dwordx4 a[208:211], v252, s[4:7], s27 offen sc1
buffer_store_dwordx4 a[212:215], v253, s[4:7], s27 offen sc1
L_bsend_15:
v_mfma_f32_16x16x32_bf16 v[36:39], a[164:167], a[128:131], v[36:39]
ds_read_b128 a[160:163], v3 offset:9216
v_mfma_f32_16x16x32_bf16 v[68:71], a[164:167], a[132:135], v[68:71]
s_waitcnt lgkmcnt(8)
v_mfma_f32_16x16x32_bf16 v[40:43], a[168:171], a[128:131], v[40:43]
ds_read_b128 a[164:167], v3 offset:10240
v_mfma_f32_16x16x32_bf16 v[72:75], a[168:171], a[132:135], v[72:75]
v_mfma_f32_16x16x32_bf16 v[44:47], a[172:175], a[128:131], v[44:47]
ds_read_b128 a[168:171], v3 offset:11264
v_mfma_f32_16x16x32_bf16 v[76:79], a[172:175], a[132:135], v[76:79]
s_waitcnt lgkmcnt(8)
v_mfma_f32_16x16x32_bf16 v[48:51], a[176:179], a[128:131], v[48:51]
ds_read_b128 a[172:175], v3 offset:12288
v_mfma_f32_16x16x32_bf16 v[80:83], a[176:179], a[132:135], v[80:83]
v_mfma_f32_16x16x32_bf16 v[52:55], a[128:131], a[180:183], v[52:55]
ds_read_b128 a[176:179], v3 offset:13312
v_mfma_f32_16x16x32_bf16 v[84:87], a[132:135], a[180:183], v[84:87]
s_waitcnt lgkmcnt(8)
v_mfma_f32_16x16x32_bf16 v[56:59], a[128:131], a[184:187], v[56:59]
ds_read_b128 a[180:183], v3 offset:14336
v_mfma_f32_16x16x32_bf16 v[88:91], a[132:135], a[184:187], v[88:91]
v_mfma_f32_16x16x32_bf16 v[60:63], a[128:131], a[188:191], v[60:63]
ds_read_b128 a[184:187], v3 offset:15360
v_mfma_f32_16x16x32_bf16 v[92:95], a[132:135], a[188:191], v[92:95]
s_waitcnt lgkmcnt(7)
v_mfma_f32_16x16x32_bf16 v[96:99], a[196:199], a[192:195], v[96:99]
ds_read_b128 a[188:191], v3 offset:16384
v_mfma_f32_16x16x32_bf16 v[100:103], a[192:195], a[200:203], v[100:103]
ds_read_b128 a[192:195], v3 offset:17408
ds_read_b128 a[196:199], v6 offset:9216
ds_read_b128 a[200:203], v9 offset:9216
s_waitcnt vmcnt(8)
s_barrier
s_waitcnt lgkmcnt(9)
v_mfma_f32_16x16x32_bf16 v[32:35], a[160:163], a[136:139], v[32:35]
v_mfma_f32_16x16x32_bf16 v[64:67], a[160:163], a[140:143], v[64:67]
s_cmp_ge_u32 s25, 192
s_cbranch_scc1 L_bshi_16
buffer_store_dwordx4 a[212:215], v2, s[4:7], s27 offen sc1
s_add_u32 s27, s27, 6144
buffer_store_dwordx4 a[216:219], v2, s[4:7], s27 offen sc1
s_add_u32 s27, s27, 6144
s_branch L_bsend_17
L_bshi_16:
buffer_store_dwordx4 a[216:219], v251, s[4:7], s29 offen sc1
buffer_store_dwordx4 a[220:223], v252, s[4:7], s29 offen sc1
buffer_store_dwordx4 a[224:227], v253, s[4:7], s29 offen sc1
L_bsend_17:
v_mfma_f32_16x16x32_bf16 v[36:39], a[164:167], a[136:139], v[36:39]
ds_read_b128 a[160:163], v3 offset:18432
v_mfma_f32_16x16x32_bf16 v[68:71], a[164:167], a[140:143], v[68:71]
s_waitcnt lgkmcnt(8)
v_mfma_f32_16x16x32_bf16 v[40:43], a[168:171], a[136:139], v[40:43]
ds_read_b128 a[164:167], v3 offset:19456
v_mfma_f32_16x16x32_bf16 v[72:75], a[168:171], a[140:143], v[72:75]
v_mfma_f32_16x16x32_bf16 v[44:47], a[172:175], a[136:139], v[44:47]
ds_read_b128 a[168:171], v3 offset:20480
v_mfma_f32_16x16x32_bf16 v[76:79], a[172:175], a[140:143], v[76:79]
s_waitcnt lgkmcnt(8)
v_mfma_f32_16x16x32_bf16 v[48:51], a[176:179], a[136:139], v[48:51]
ds_read_b128 a[172:175], v3 offset:21504
v_mfma_f32_16x16x32_bf16 v[80:83], a[176:179], a[140:143], v[80:83]
v_mfma_f32_16x16x32_bf16 v[52:55], a[136:139], a[180:183], v[52:55]
ds_read_b128 a[176:179], v3 offset:22528
v_mfma_f32_16x16x32_bf16 v[84:87], a[140:143], a[180:183], v[84:87]
s_waitcnt lgkmcnt(8)
v_mfma_f32_16x16x32_bf16 v[56:59], a[136:139], a[184:187], v[56:59]
ds_read_b128 a[180:183], v3 offset:23552
v_mfma_f32_16x16x32_bf16 v[88:91], a[140:143], a[184:187], v[88:91]
v_mfma_f32_16x16x32_bf16 v[60:63], a[136:139], a[188:191], v[60:63]
ds_read_b128 a[184:187], v3 offset:24576
v_mfma_f32_16x16x32_bf16 v[92:95], a[140:143], a[188:191], v[92:95]
s_waitcnt lgkmcnt(7)
v_mfma_f32_16x16x32_bf16 v[96:99], a[196:199], a[192:195], v[96:99]
ds_read_b128 a[188:191], v3 offset:25600
v_mfma_f32_16x16x32_bf16 v[100:103], a[192:195], a[200:203], v[100:103]
ds_read_b128 a[192:195], v3 offset:26624
ds_read_b128 a[196:199], v6 offset:18432
ds_read_b128 a[200:203], v9 offset:18432
s_waitcnt vmcnt(6)
s_barrier
s_waitcnt lgkmcnt(9)
v_mfma_f32_16x16x32_bf16 v[32:35], a[160:163], a[144:147], v[32:35]
v_mfma_f32_16x16x32_bf16 v[64:67], a[160:163], a[148:151], v[64:67]
s_cmp_ge_u32 s25, 192
s_cbranch_scc1 L_bshi_18
buffer_store_dwordx4 a[220:223], v2, s[4:7], s27 offen sc1
buffer_store_dword v238, v239, s[4:7], s28 offen sc1
s_branch L_bsend_19
L_bshi_18:
buffer_store_dwordx4 a[228:231], v251, s[4:7], s31 offen sc1
buffer_store_dwordx4 a[232:235], v252, s[4:7], s31 offen sc1
buffer_store_dwordx4 a[236:239], v253, s[4:7], s31 offen sc1
L_bsend_19:
v_mfma_f32_16x16x32_bf16 v[36:39], a[164:167], a[144:147], v[36:39]
ds_read_b128 a[160:163], v3 offset:27648
v_mfma_f32_16x16x32_bf16 v[68:71], a[164:167], a[148:151], v[68:71]
s_waitcnt lgkmcnt(8)
v_mfma_f32_16x16x32_bf16 v[40:43], a[168:171], a[144:147], v[40:43]
ds_read_b128 a[164:167], v3 offset:28672
v_mfma_f32_16x16x32_bf16 v[72:75], a[168:171], a[148:151], v[72:75]
v_mfma_f32_16x16x32_bf16 v[44:47], a[172:175], a[144:147], v[44:47]
ds_read_b128 a[168:171], v3 offset:29696
v_mfma_f32_16x16x32_bf16 v[76:79], a[172:175], a[148:151], v[76:79]
s_waitcnt lgkmcnt(8)
v_mfma_f32_16x16x32_bf16 v[48:51], a[176:179], a[144:147], v[48:51]
ds_read_b128 a[172:175], v3 offset:30720
v_mfma_f32_16x16x32_bf16 v[80:83], a[176:179], a[148:151], v[80:83]
v_mfma_f32_16x16x32_bf16 v[52:55], a[144:147], a[180:183], v[52:55]
ds_read_b128 a[176:179], v3 offset:31744
v_mfma_f32_16x16x32_bf16 v[84:87], a[148:151], a[180:183], v[84:87]
s_waitcnt lgkmcnt(8)
v_mfma_f32_16x16x32_bf16 v[56:59], a[144:147], a[184:187], v[56:59]
ds_read_b128 a[180:183], v3 offset:32768
v_mfma_f32_16x16x32_bf16 v[88:91], a[148:151], a[184:187], v[88:91]
v_mfma_f32_16x16x32_bf16 v[60:63], a[144:147], a[188:191], v[60:63]
ds_read_b128 a[184:187], v3 offset:33792
v_mfma_f32_16x16x32_bf16 v[92:95], a[148:151], a[188:191], v[92:95]
s_waitcnt lgkmcnt(7)
v_mfma_f32_16x16x32_bf16 v[96:99], a[196:199], a[192:195], v[96:99]
ds_read_b128 a[188:191], v3 offset:34816
v_mfma_f32_16x16x32_bf16 v[100:103], a[192:195], a[200:203], v[100:103]
ds_read_b128 a[192:195], v3 offset:35840
ds_read_b128 a[196:199], v6 offset:27648
ds_read_b128 a[200:203], v9 offset:27648
s_waitcnt vmcnt(6) lgkmcnt(9)
v_mfma_f32_16x16x32_bf16 v[32:35], a[160:163], a[152:155], v[32:35]
v_mfma_f32_16x16x32_bf16 v[64:67], a[160:163], a[156:159], v[64:67]
v_mfma_f32_16x16x32_bf16 v[36:39], a[164:167], a[152:155], v[36:39]
v_mfma_f32_16x16x32_bf16 v[68:71], a[164:167], a[156:159], v[68:71]
s_waitcnt lgkmcnt(7)
v_mfma_f32_16x16x32_bf16 v[40:43], a[168:171], a[152:155], v[40:43]
v_mfma_f32_16x16x32_bf16 v[72:75], a[168:171], a[156:159], v[72:75]
v_mfma_f32_16x16x32_bf16 v[44:47], a[172:175], a[152:155], v[44:47]
v_mfma_f32_16x16x32_bf16 v[76:79], a[172:175], a[156:159], v[76:79]
s_waitcnt lgkmcnt(5)
v_mfma_f32_16x16x32_bf16 v[48:51], a[176:179], a[152:155], v[48:51]
v_mfma_f32_16x16x32_bf16 v[80:83], a[176:179], a[156:159], v[80:83]
v_mfma_f32_16x16x32_bf16 v[52:55], a[152:155], a[180:183], v[52:55]
v_mfma_f32_16x16x32_bf16 v[84:87], a[156:159], a[180:183], v[84:87]
s_waitcnt lgkmcnt(3)
v_mfma_f32_16x16x32_bf16 v[56:59], a[152:155], a[184:187], v[56:59]
v_mfma_f32_16x16x32_bf16 v[88:91], a[156:159], a[184:187], v[88:91]
v_mfma_f32_16x16x32_bf16 v[60:63], a[152:155], a[188:191], v[60:63]
v_mfma_f32_16x16x32_bf16 v[92:95], a[156:159], a[188:191], v[92:95]
s_waitcnt lgkmcnt(0)
v_mfma_f32_16x16x32_bf16 v[96:99], a[196:199], a[192:195], v[96:99]
v_mfma_f32_16x16x32_bf16 v[100:103], a[192:195], a[200:203], v[100:103]
v_cvt_pk_bf16_f32 v128, v68, v69
v_cvt_pk_bf16_f32 v129, v70, v71
v_cvt_pk_bf16_f32 v130, v81, 0
v_cvt_pk_bf16_f32 v132, v76, v77
v_cvt_pk_bf16_f32 v133, v78, v79
v_cvt_pk_bf16_f32 v134, v83, 0
v_cvt_pk_bf16_f32 v148, v84, v85
v_cvt_pk_bf16_f32 v149, v86, v87
v_cvt_pk_bf16_f32 v154, v88, v89
v_cvt_pk_bf16_f32 v155, v90, v91
v_cvt_pk_bf16_f32 v160, v92, v93
v_cvt_pk_bf16_f32 v161, v94, v95
ds_write_b128 v226, v[128:131]
ds_write_b128 v226, v[132:135] offset:1024
ds_write_b64 v226, v[148:149] offset:2048
ds_write_b64 v226, v[154:155] offset:2056
ds_write_b64 v226, v[160:161] offset:3072
v_cvt_pk_bf16_f32 v16, v96, v97
v_cvt_pk_bf16_f32 v17, v98, v99
v_cvt_pk_bf16_f32 v18, v97, 0
v_cvt_pk_bf16_f32 v19, v99, 0
v_cvt_pk_bf16_f32 v20, v100, v101
v_cvt_pk_bf16_f32 v21, v102, v103
v_cndmask_b32 v16, v16, v18, s[42:43]
v_cndmask_b32 v17, v17, v19, s[42:43]
v_cndmask_b32 v16, v16, v107, s[44:45]
v_cndmask_b32 v17, v17, v107, s[44:45]
ds_write_b32 v228, v16
ds_write_b32 v229, v17
ds_write_b64 v230, v[20:21] offset:2048
v_cvt_pk_bf16_f32 v120, v36, v37
v_cvt_pk_bf16_f32 v121, v38, v39
v_cvt_pk_bf16_f32 v122, v49, 0
v_cvt_pk_bf16_f32 v124, v44, v45
v_cvt_pk_bf16_f32 v125, v46, v47
v_cvt_pk_bf16_f32 v126, v51, 0
v_cvt_pk_bf16_f32 v146, v52, v53
v_cvt_pk_bf16_f32 v147, v54, v55
v_cvt_pk_bf16_f32 v152, v56, v57
v_cvt_pk_bf16_f32 v153, v58, v59
v_cvt_pk_bf16_f32 v158, v60, v61
v_cvt_pk_bf16_f32 v159, v62, v63
v_cvt_pk_bf16_f32 v112, v64, v65
v_cvt_pk_bf16_f32 v113, v66, v67
v_cvt_pk_bf16_f32 v114, v80, 0
v_cvt_pk_bf16_f32 v116, v72, v73
v_cvt_pk_bf16_f32 v117, v74, v75
v_cvt_pk_bf16_f32 v118, v82, 0
v_cvt_pk_bf16_f32 v104, v32, v33
v_cvt_pk_bf16_f32 v105, v34, v35
v_cvt_pk_bf16_f32 v106, v48, 0
v_cvt_pk_bf16_f32 v108, v40, v41
v_cvt_pk_bf16_f32 v109, v42, v43
v_cvt_pk_bf16_f32 v110, v50, 0
s_waitcnt lgkmcnt(0)
s_barrier
ds_read_b128 v[136:139], v227
ds_read_b128 v[140:143], v227 offset:1024
ds_read_b64 v[144:145], v227 offset:2048
ds_read_b64 v[150:151], v227 offset:2056
ds_read_b64 v[156:157], v227 offset:3072
buffer_load_dwordx2 v[82:83], v250, s[8:11], 0 offen offset:0
buffer_load_dwordx2 v[84:85], v250, s[8:11], 0 offen offset:32
buffer_load_dwordx2 v[86:87], v250, s[8:11], 0 offen offset:64
buffer_load_dwordx2 v[88:89], v250, s[8:11], 0 offen offset:96
buffer_load_dwordx2 v[90:91], v250, s[8:11], 0 offen offset:128
v_mfma_f32_16x16x32_bf16 v[182:185], v[120:123], v[104:107], v[166:169]
v_mfma_f32_16x16x32_bf16 v[190:193], v[124:127], v[108:111], v[166:169]
v_mfma_f32_16x16x32_bf16 v[198:201], v[128:131], v[112:115], v[166:169]
v_mfma_f32_16x16x32_bf16 v[206:209], v[132:135], v[116:119], v[166:169]
v_mfma_f32_16x16x32_bf16 v[194:197], v[120:123], v[112:115], v[170:173]
v_mfma_f32_16x16x32_bf16 v[202:205], v[124:127], v[116:119], v[170:173]
s_waitcnt lgkmcnt(3)
v_mfma_f32_16x16x32_bf16 v[178:181], v[136:139], v[104:107], v[174:177]
v_mfma_f32_16x16x32_bf16 v[186:189], v[140:143], v[108:111], v[174:177]
s_nop 3
v_max3_f32 v22, v194, v195, v196
v_max3_f32 v26, v202, v203, v204
s_nop 0
v_max3_f32 v14, v178, v179, v180
v_max3_f32 v18, v186, v187, v188
v_max3_f32 v23, v197, v198, v199
v_max3_f32 v27, v205, v206, v207
v_max3_f32 v15, v181, v182, v183
v_max3_f32 v19, v189, v190, v191
v_max3_f32 v22, v200, v201, v22
v_max3_f32 v26, v208, v209, v26
v_max3_f32 v14, v184, v185, v14
v_max3_f32 v18, v192, v193, v18
v_max_f32 v22, v22, v23
v_max_f32 v26, v26, v27
v_max_f32 v14, v14, v15
v_max_f32 v18, v18, v19
v_mov_b32 v23, v22
v_mov_b32 v27, v26
v_mov_b32 v15, v14
v_mov_b32 v19, v18
v_permlane32_swap_b32 v22, v23
v_permlane32_swap_b32 v26, v27
v_permlane32_swap_b32 v14, v15
v_permlane32_swap_b32 v18, v19
v_max_f32 v22, v22, v23
v_max_f32 v26, v26, v27
v_max_f32 v14, v14, v15
v_max_f32 v18, v18, v19
v_mov_b32 v23, v22
v_mov_b32 v27, v26
v_mov_b32 v15, v14
v_mov_b32 v19, v18
v_permlane16_swap_b32 v22, v23
v_permlane16_swap_b32 v26, v27
v_permlane16_swap_b32 v14, v15
v_permlane16_swap_b32 v18, v19
v_max_f32 v22, v22, v23
v_max_f32 v26, v26, v27
v_max_f32 v14, v14, v15
v_max_f32 v18, v18, v19
v_mul_f32 v22, s48, v22
v_mul_f32 v26, s48, v26
v_mul_f32 v14, s48, v14
v_mul_f32 v18, s48, v18
v_pk_fma_f32 v[194:195], v[194:195], s[48:49], v[22:23] op_sel_hi:[1,0,0] neg_lo:[0,0,1] neg_hi:[0,0,1]
v_pk_fma_f32 v[202:203], v[202:203], s[48:49], v[26:27] op_sel_hi:[1,0,0] neg_lo:[0,0,1] neg_hi:[0,0,1]
v_pk_fma_f32 v[178:179], v[178:179], s[48:49], v[14:15] op_sel_hi:[1,0,0] neg_lo:[0,0,1] neg_hi:[0,0,1]
v_pk_fma_f32 v[186:187], v[186:187], s[48:49], v[18:19] op_sel_hi:[1,0,0] neg_lo:[0,0,1] neg_hi:[0,0,1]
v_pk_fma_f32 v[196:197], v[196:197], s[48:49], v[22:23] op_sel_hi:[1,0,0] neg_lo:[0,0,1] neg_hi:[0,0,1]
v_pk_fma_f32 v[204:205], v[204:205], s[48:49], v[26:27] op_sel_hi:[1,0,0] neg_lo:[0,0,1] neg_hi:[0,0,1]
v_pk_fma_f32 v[180:181], v[180:181], s[48:49], v[14:15] op_sel_hi:[1,0,0] neg_lo:[0,0,1] neg_hi:[0,0,1]
v_pk_fma_f32 v[188:189], v[188:189], s[48:49], v[18:19] op_sel_hi:[1,0,0] neg_lo:[0,0,1] neg_hi:[0,0,1]
v_pk_fma_f32 v[198:199], v[198:199], s[48:49], v[22:23] op_sel_hi:[1,0,0] neg_lo:[0,0,1] neg_hi:[0,0,1]
v_pk_fma_f32 v[206:207], v[206:207], s[48:49], v[26:27] op_sel_hi:[1,0,0] neg_lo:[0,0,1] neg_hi:[0,0,1]
v_pk_fma_f32 v[182:183], v[182:183], s[48:49], v[14:15] op_sel_hi:[1,0,0] neg_lo:[0,0,1] neg_hi:[0,0,1]
v_pk_fma_f32 v[190:191], v[190:191], s[48:49], v[18:19] op_sel_hi:[1,0,0] neg_lo:[0,0,1] neg_hi:[0,0,1]
v_pk_fma_f32 v[200:201], v[200:201], s[48:49], v[22:23] op_sel_hi:[1,0,0] neg_lo:[0,0,1] neg_hi:[0,0,1]
v_pk_fma_f32 v[208:209], v[208:209], s[48:49], v[26:27] op_sel_hi:[1,0,0] neg_lo:[0,0,1] neg_hi:[0,0,1]
v_pk_fma_f32 v[184:185], v[184:185], s[48:49], v[14:15] op_sel_hi:[1,0,0] neg_lo:[0,0,1] neg_hi:[0,0,1]
v_pk_fma_f32 v[192:193], v[192:193], s[48:49], v[18:19] op_sel_hi:[1,0,0] neg_lo:[0,0,1] neg_hi:[0,0,1]
v_exp_f32 v194, v194
v_exp_f32 v202, v202
v_exp_f32 v178, v178
v_exp_f32 v186, v186
v_exp_f32 v195, v195
v_exp_f32 v203, v203
v_exp_f32 v179, v179
v_exp_f32 v187, v187
v_exp_f32 v196, v196
v_exp_f32 v204, v204
v_exp_f32 v180, v180
v_exp_f32 v188, v188
v_exp_f32 v197, v197
v_exp_f32 v205, v205
v_exp_f32 v181, v181
v_exp_f32 v189, v189
v_exp_f32 v198, v198
v_exp_f32 v206, v206
v_exp_f32 v182, v182
v_exp_f32 v190, v190
v_exp_f32 v199, v199
v_exp_f32 v207, v207
v_exp_f32 v183, v183
v_exp_f32 v191, v191
v_exp_f32 v200, v200
v_exp_f32 v208, v208
v_exp_f32 v184, v184
v_exp_f32 v192, v192
v_exp_f32 v201, v201
v_exp_f32 v209, v209
v_exp_f32 v185, v185
v_exp_f32 v193, v193
v_cvt_pk_bf16_f32 v218, v194, v195
v_cvt_pk_bf16_f32 v222, v202, v203
v_cvt_pk_bf16_f32 v210, v178, v179
v_cvt_pk_bf16_f32 v214, v186, v187
v_cvt_pk_bf16_f32 v219, v196, v197
v_cvt_pk_bf16_f32 v223, v204, v205
v_cvt_pk_bf16_f32 v211, v180, v181
v_cvt_pk_bf16_f32 v215, v188, v189
v_cvt_pk_bf16_f32 v220, v198, v199
v_cvt_pk_bf16_f32 v224, v206, v207
v_cvt_pk_bf16_f32 v212, v182, v183
v_cvt_pk_bf16_f32 v216, v190, v191
v_cvt_pk_bf16_f32 v221, v200, v201
v_cvt_pk_bf16_f32 v225, v208, v209
v_cvt_pk_bf16_f32 v213, v184, v185
v_cvt_pk_bf16_f32 v217, v192, v193
s_waitcnt lgkmcnt(0)
v_mfma_f32_16x16x32_bf16 v[64:67], v[162:165], v[218:221], 0
v_mfma_f32_16x16x32_bf16 v[56:59], v[146:149], v[218:221], 0
v_mfma_f32_16x16x32_bf16 v[60:63], v[158:161], v[218:221], 0
v_mfma_f32_16x16x32_bf16 v[76:79], v[162:165], v[222:225], 0
v_mfma_f32_16x16x32_bf16 v[68:71], v[152:155], v[222:225], 0
v_mfma_f32_16x16x32_bf16 v[72:75], v[158:161], v[222:225], 0
v_mfma_f32_16x16x32_bf16 v[40:43], v[162:165], v[210:213], 0
v_mfma_f32_16x16x32_bf16 v[32:35], v[144:147], v[210:213], 0
v_mfma_f32_16x16x32_bf16 v[36:39], v[156:159], v[210:213], 0
v_mfma_f32_16x16x32_bf16 v[52:55], v[162:165], v[214:217], 0
v_mfma_f32_16x16x32_bf16 v[44:47], v[150:153], v[214:217], 0
v_mfma_f32_16x16x32_bf16 v[48:51], v[156:159], v[214:217], 0
v_rcp_f32 v64, v64
v_rcp_f32 v76, v76
s_nop 0
v_rcp_f32 v40, v40
s_nop 1
v_rcp_f32 v52, v52
v_pk_mul_f32 v[56:57], v[56:57], v[64:65] op_sel_hi:[1,0]
v_pk_mul_f32 v[68:69], v[68:69], v[76:77] op_sel_hi:[1,0]
v_pk_mul_f32 v[32:33], v[32:33], v[40:41] op_sel_hi:[1,0]
v_pk_mul_f32 v[44:45], v[44:45], v[52:53] op_sel_hi:[1,0]
v_pk_mul_f32 v[58:59], v[58:59], v[64:65] op_sel_hi:[1,0]
v_pk_mul_f32 v[70:71], v[70:71], v[76:77] op_sel_hi:[1,0]
v_pk_mul_f32 v[34:35], v[34:35], v[40:41] op_sel_hi:[1,0]
v_pk_mul_f32 v[46:47], v[46:47], v[52:53] op_sel_hi:[1,0]
v_pk_mul_f32 v[60:61], v[60:61], v[64:65] op_sel_hi:[1,0]
v_pk_mul_f32 v[72:73], v[72:73], v[76:77] op_sel_hi:[1,0]
v_pk_mul_f32 v[36:37], v[36:37], v[40:41] op_sel_hi:[1,0]
v_pk_mul_f32 v[48:49], v[48:49], v[52:53] op_sel_hi:[1,0]
v_pk_mul_f32 v[62:63], v[62:63], v[64:65] op_sel_hi:[1,0]
v_pk_mul_f32 v[74:75], v[74:75], v[76:77] op_sel_hi:[1,0]
v_pk_mul_f32 v[38:39], v[38:39], v[40:41] op_sel_hi:[1,0]
v_pk_mul_f32 v[50:51], v[50:51], v[52:53] op_sel_hi:[1,0]
v_cvt_pk_bf16_f32 v112, v56, v57
v_cvt_pk_bf16_f32 v113, v58, v59
v_cvt_pk_bf16_f32 v114, v68, v69
v_cvt_pk_bf16_f32 v115, v70, v71
v_cvt_pk_bf16_f32 v116, v60, v61
v_cvt_pk_bf16_f32 v117, v62, v63
v_cvt_pk_bf16_f32 v76, v72, v73
v_cvt_pk_bf16_f32 v77, v74, v75
v_cndmask_b32 v116, v116, v76, s[46:47]
v_cndmask_b32 v117, v117, v77, s[46:47]
v_cvt_pk_bf16_f32 v104, v32, v33
v_cvt_pk_bf16_f32 v105, v34, v35
v_cvt_pk_bf16_f32 v106, v44, v45
v_cvt_pk_bf16_f32 v107, v46, v47
v_cvt_pk_bf16_f32 v108, v36, v37
v_cvt_pk_bf16_f32 v109, v38, v39
v_cvt_pk_bf16_f32 v52, v48, v49
v_cvt_pk_bf16_f32 v53, v50, v51
v_cndmask_b32 v108, v108, v52, s[46:47]
v_cndmask_b32 v109, v109, v53, s[46:47]
s_add_u32 s37, s40, 20480
s_add_u32 s38, s41, 20480
buffer_store_dwordx4 v[112:115], v2, s[4:7], s37 offen sc1
buffer_store_dwordx2 v[116:117], v231, s[4:7], s38 offen sc1
buffer_store_dwordx4 v[104:107], v2, s[4:7], s40 offen sc1
buffer_store_dwordx2 v[108:109], v231, s[4:7], s41 offen sc1
s_lshl_b32 s64, s16, 10
s_mul_i32 s65, s60, 102400
s_add_u32 s65, s65, 0x790000
s_add_u32 s65, s65, s64
s_add_u32 m0, s64, 36864
s_add_u32 s37, s65, 0
buffer_load_dwordx4 v2, s[4:7], s37 offen sc1 lds
s_add_u32 m0, s64, 40960
s_add_u32 s37, s65, 4096
buffer_load_dwordx4 v2, s[4:7], s37 offen sc1 lds
s_add_u32 m0, s64, 45056
s_add_u32 s37, s65, 8192
buffer_load_dwordx4 v2, s[4:7], s37 offen sc1 lds
s_add_u32 m0, s64, 49152
s_add_u32 s37, s65, 12288
buffer_load_dwordx4 v2, s[4:7], s37 offen sc1 lds
s_add_u32 m0, s64, 53248
s_add_u32 s37, s65, 16384
buffer_load_dwordx4 v2, s[4:7], s37 offen sc1 lds
s_add_u32 m0, s64, 57344
s_add_u32 s37, s65, 20480
buffer_load_dwordx4 v2, s[4:7], s37 offen sc1 lds
s_add_u32 m0, s64, 61440
s_add_u32 s37, s65, 24576
buffer_load_dwordx4 v2, s[4:7], s37 offen sc1 lds
s_add_u32 m0, s64, 65536
s_add_u32 s37, s65, 28672
buffer_load_dwordx4 v2, s[4:7], s37 offen sc1 lds
s_add_u32 m0, s64, 69632
s_add_u32 s37, s65, 32768
buffer_load_dwordx4 v2, s[4:7], s37 offen sc1 lds
s_add_u32 m0, s64, 73728
s_add_u32 s37, s65, 36864
buffer_load_dwordx4 v2, s[4:7], s37 offen sc1 lds
s_add_u32 m0, s64, 77824
s_add_u32 s37, s65, 40960
buffer_load_dwordx4 v2, s[4:7], s37 offen sc1 lds
s_add_u32 m0, s64, 81920
s_add_u32 s37, s65, 45056
buffer_load_dwordx4 v2, s[4:7], s37 offen sc1 lds
s_add_u32 m0, s64, 86016
s_add_u32 s37, s65, 49152
buffer_load_dwordx4 v2, s[4:7], s37 offen sc1 lds
s_lshl_b32 s50, s17, 3
s_lshl_b32 s51, s61, 2
s_add_u32 s50, s50, s51
s_add_u32 s50, s50, s16
s_mul_i32 s20, s50, 20480
s_mul_i32 s51, s63, 10240
s_add_u32 s20, s20, s51
s_add_u32 s20, s20, 0x510000
s_cmp_eq_u32 s63, 0
s_cselect_b32 s51, 0, 20480
s_cselect_b32 s52, 20480, 0
s_sub_u32 s20, s20, s51
v_add_u32 v7, s51, v2
v_add_u32 v6, s52, v2
s_mul_i32 s51, s63, 5120
v_add_u32 v3, s51, v2
v_add_u32 v4, 61440, v3
v_add_u32 v5, 122880, v3
s_mul_i32 s50, s16, 5120
v_add_u32 v8, s50, v2
s_xor_b32 s51, s16, 1
s_mul_i32 s51, s51, 5120
v_add_u32 v9, s51, v2
s_lshl_b32 s50, s17, 2
s_lshl_b32 s51, s61, 1
s_add_u32 s50, s50, s51
s_add_u32 s50, s50, s62
s_mul_i32 s50, s50, 40960
s_mul_i32 s51, s60, 5120
s_add_u32 s50, s50, s51
s_lshl_b32 s51, s63, 8
s_add_u32 s50, s50, s51
s_add_u32 s40, s50, 0x858000
v_and_b32 v14, 15, v1
v_lshlrev_b32 v15, 4, v14
v_bfe_u32 v16, v1, 5, 1
v_lshl_add_u32 v15, v16, 9, v15
v_bfe_u32 v16, v1, 4, 1
v_lshl_add_u32 v232, v16, 3, v15
s_lshl_b32 s50, s17, 7
s_lshl_b32 s51, s61, 6
s_add_u32 s50, s50, s51
s_lshl_b32 s51, s16, 4
s_add_u32 s50, s50, s51
s_lshl_b32 s50, s50, 6
s_lshl_b32 s51, s60, 3
s_add_u32 s50, s50, s51
s_add_u32 s41, s50, 0xad8000
v_lshlrev_b32 v15, 6, v14
v_mov_b32 v16, 0x7ff00000
v_cmp_gt_u32 vcc, 16, v1
s_nop 1
v_cndmask_b32 v233, v16, v15, vcc
s_mul_i32 s21, s16, 3072
s_mul_i32 s22, s18, 245760
s_add_u32 s22, s22, 0xaf8000
s_add_u32 s22, s22, s21
s_waitcnt vmcnt(13)
s_barrier
s_cmp_lg_u32 s16, 0
s_cbranch_scc1 L_arr_20
s_lshl_b32 s3, s17, 7
s_add_u32 s3, s3, 0x3000
v_mov_b32 v14, s3
v_mov_b32 v15, 1
s_mov_b64 exec, 1
buffer_atomic_add v15, v14, s[4:7], 0 offen sc1
s_mov_b64 exec, -1
L_arr_20:
s_cmp_lg_u32 s16, 0
s_cbranch_scc1 L_arr_21
s_lshl_b32 s3, s17, 7
s_add_u32 s3, s3, 0x4800
v_mov_b32 v14, s3
v_mov_b32 v15, 1
s_mov_b64 exec, 1
buffer_atomic_add v15, v14, s[4:7], 0 offen sc1
s_mov_b64 exec, -1
L_arr_21:
s_add_u32 m0, s64, 90112
s_add_u32 s37, s65, 53248
buffer_load_dwordx4 v2, s[4:7], s37 offen sc1 lds
s_add_u32 m0, s64, 94208
s_add_u32 s37, s65, 57344
buffer_load_dwordx4 v2, s[4:7], s37 offen sc1 lds
s_add_u32 m0, s64, 98304
s_add_u32 s37, s65, 61440
buffer_load_dwordx4 v2, s[4:7], s37 offen sc1 lds
s_add_u32 m0, s64, 102400
s_add_u32 s37, s65, 65536
buffer_load_dwordx4 v2, s[4:7], s37 offen sc1 lds
s_add_u32 m0, s64, 106496
s_add_u32 s37, s65, 69632
buffer_load_dwordx4 v2, s[4:7], s37 offen sc1 lds
s_add_u32 m0, s64, 110592
s_add_u32 s37, s65, 73728
buffer_load_dwordx4 v2, s[4:7], s37 offen sc1 lds
s_add_u32 m0, s64, 114688
s_add_u32 s37, s65, 77824
buffer_load_dwordx4 v2, s[4:7], s37 offen sc1 lds
s_add_u32 m0, s64, 118784
s_add_u32 s37, s65, 81920
buffer_load_dwordx4 v2, s[4:7], s37 offen sc1 lds
s_add_u32 m0, s64, 122880
s_add_u32 s37, s65, 86016
buffer_load_dwordx4 v2, s[4:7], s37 offen sc1 lds
s_add_u32 m0, s64, 126976
s_add_u32 s37, s65, 90112
buffer_load_dwordx4 v2, s[4:7], s37 offen sc1 lds
s_add_u32 m0, s64, 131072
s_add_u32 s37, s65, 94208
buffer_load_dwordx4 v2, s[4:7], s37 offen sc1 lds
s_add_u32 m0, s64, 135168
s_add_u32 s37, s65, 98304
buffer_load_dwordx4 v2, s[4:7], s37 offen sc1 lds
s_cmp_lg_u32 s16, 0
s_cbranch_scc1 L_wg_g1_22
s_lshl_b32 s3, s17, 7
s_add_u32 s3, s3, 0x3000
v_mov_b32 v14, s3
s_add_u32 s37, s19, 16
s_mov_b32 s3, 0
L_poll_g1_23:
buffer_load_dword v16, v14, s[4:7], 0 offen sc1
s_add_u32 s3, s3, 1
s_cmp_gt_u32 s3, 400000
s_cbranch_scc1 L_polld_g1_24
s_waitcnt vmcnt(0)
v_cmp_ne_u32 vcc, s37, v16
s_nop 3
s_cmp_eq_u64 vcc, 0
s_cbranch_scc0 L_poll_g1_23
L_polld_g1_24:
s_waitcnt vmcnt(0)
L_wg_g1_22:
s_barrier
s_add_u32 s38, s20, 0
buffer_load_dwordx4 a[0:3], v7, s[4:7], s38 offen offset:0 sc1
buffer_load_dwordx4 a[4:7], v6, s[4:7], s38 offen offset:0 sc1
buffer_load_dwordx4 a[8:11], v7, s[4:7], s38 offen offset:1024 sc1
buffer_load_dwordx4 a[12:15], v6, s[4:7], s38 offen offset:1024 sc1
buffer_load_dwordx4 a[16:19], v7, s[4:7], s38 offen offset:2048 sc1
buffer_load_dwordx4 a[20:23], v6, s[4:7], s38 offen offset:2048 sc1
buffer_load_dwordx4 a[24:27], v7, s[4:7], s38 offen offset:3072 sc1
buffer_load_dwordx4 a[28:31], v6, s[4:7], s38 offen offset:3072 sc1
s_barrier
ds_read_b128 a[200:203], v3 offset:36864
ds_read_b128 a[204:207], v3 offset:37888
ds_read_b128 a[208:211], v3 offset:38912
ds_read_b128 a[212:215], v3 offset:39936
ds_read_b128 a[216:219], v3 offset:40960
s_waitcnt vmcnt(6) lgkmcnt(0)
v_mfma_f32_16x16x32_bf16 v[32:35], a[200:203], a[0:3], 0
ds_read_b128 a[220:223], v3 offset:47104
v_mfma_f32_16x16x32_bf16 v[52:55], a[200:203], a[4:7], 0
s_add_u32 s38, s20, 4096
buffer_load_dwordx4 a[32:35], v7, s[4:7], s38 offen offset:0 sc1
v_mfma_f32_16x16x32_bf16 v[36:39], a[204:207], a[0:3], 0
ds_read_b128 a[224:227], v3 offset:48128
v_mfma_f32_16x16x32_bf16 v[56:59], a[204:207], a[4:7], 0
buffer_load_dwordx4 a[36:39], v6, s[4:7], s38 offen offset:0 sc1
v_mfma_f32_16x16x32_bf16 v[40:43], a[208:211], a[0:3], 0
ds_read_b128 a[228:231], v3 offset:49152
v_mfma_f32_16x16x32_bf16 v[60:63], a[208:211], a[4:7], 0
buffer_load_dwordx4 a[40:43], v7, s[4:7], s38 offen offset:1024 sc1
v_mfma_f32_16x16x32_bf16 v[44:47], a[212:215], a[0:3], 0
ds_read_b128 a[232:235], v3 offset:50176
v_mfma_f32_16x16x32_bf16 v[64:67], a[212:215], a[4:7], 0
buffer_load_dwordx4 a[44:47], v6, s[4:7], s38 offen offset:1024 sc1
v_mfma_f32_16x16x32_bf16 v[48:51], a[216:219], a[0:3], 0
ds_read_b128 a[236:239], v3 offset:51200
v_mfma_f32_16x16x32_bf16 v[68:71], a[216:219], a[4:7], 0
s_waitcnt vmcnt(8) lgkmcnt(0)
v_mfma_f32_16x16x32_bf16 v[32:35], a[220:223], a[8:11], v[32:35]
ds_read_b128 a[200:203], v3 offset:57344
v_mfma_f32_16x16x32_bf16 v[52:55], a[220:223], a[12:15], v[52:55]
buffer_load_dwordx4 a[48:51], v7, s[4:7], s38 offen offset:2048 sc1
v_mfma_f32_16x16x32_bf16 v[36:39], a[224:227], a[8:11], v[36:39]
ds_read_b128 a[204:207], v3 offset:58368
v_mfma_f32_16x16x32_bf16 v[56:59], a[224:227], a[12:15], v[56:59]
buffer_load_dwordx4 a[52:55], v6, s[4:7], s38 offen offset:2048 sc1
v_mfma_f32_16x16x32_bf16 v[40:43], a[228:231], a[8:11], v[40:43]
ds_read_b128 a[208:211], v3 offset:59392
v_mfma_f32_16x16x32_bf16 v[60:63], a[228:231], a[12:15], v[60:63]
buffer_load_dwordx4 a[56:59], v7, s[4:7], s38 offen offset:3072 sc1
v_mfma_f32_16x16x32_bf16 v[44:47], a[232:235], a[8:11], v[44:47]
ds_read_b128 a[212:215], v3 offset:60416
v_mfma_f32_16x16x32_bf16 v[64:67], a[232:235], a[12:15], v[64:67]
buffer_load_dwordx4 a[60:63], v6, s[4:7], s38 offen offset:3072 sc1
v_mfma_f32_16x16x32_bf16 v[48:51], a[236:239], a[8:11], v[48:51]
ds_read_b128 a[216:219], v4 offset:0
v_mfma_f32_16x16x32_bf16 v[68:71], a[236:239], a[12:15], v[68:71]
s_waitcnt vmcnt(10) lgkmcnt(0)
v_mfma_f32_16x16x32_bf16 v[32:35], a[200:203], a[16:19], v[32:35]
ds_read_b128 a[220:223], v4 offset:6144
v_mfma_f32_16x16x32_bf16 v[52:55], a[200:203], a[20:23], v[52:55]
s_add_u32 s38, s20, 8192
buffer_load_dwordx4 a[64:67], v7, s[4:7], s38 offen offset:0 sc1
v_mfma_f32_16x16x32_bf16 v[36:39], a[204:207], a[16:19], v[36:39]
ds_read_b128 a[224:227], v4 offset:7168
v_mfma_f32_16x16x32_bf16 v[56:59], a[204:207], a[20:23], v[56:59]
buffer_load_dwordx4 a[68:71], v6, s[4:7], s38 offen offset:0 sc1
v_mfma_f32_16x16x32_bf16 v[40:43], a[208:211], a[16:19], v[40:43]
ds_read_b128 a[228:231], v4 offset:8192
v_mfma_f32_16x16x32_bf16 v[60:63], a[208:211], a[20:23], v[60:63]
buffer_load_dwordx4 a[72:75], v7, s[4:7], s38 offen offset:1024 sc1
v_mfma_f32_16x16x32_bf16 v[44:47], a[212:215], a[16:19], v[44:47]
ds_read_b128 a[232:235], v4 offset:9216
v_mfma_f32_16x16x32_bf16 v[64:67], a[212:215], a[20:23], v[64:67]
buffer_load_dwordx4 a[76:79], v6, s[4:7], s38 offen offset:1024 sc1
v_mfma_f32_16x16x32_bf16 v[48:51], a[216:219], a[16:19], v[48:51]
ds_read_b128 a[236:239], v4 offset:10240
v_mfma_f32_16x16x32_bf16 v[68:71], a[216:219], a[20:23], v[68:71]
s_waitcnt vmcnt(12) lgkmcnt(0)
v_mfma_f32_16x16x32_bf16 v[32:35], a[220:223], a[24:27], v[32:35]
ds_read_b128 a[200:203], v4 offset:16384
v_mfma_f32_16x16x32_bf16 v[52:55], a[220:223], a[28:31], v[52:55]
v_mfma_f32_16x16x32_bf16 v[36:39], a[224:227], a[24:27], v[36:39]
ds_read_b128 a[204:207], v4 offset:17408
v_mfma_f32_16x16x32_bf16 v[56:59], a[224:227], a[28:31], v[56:59]
v_mfma_f32_16x16x32_bf16 v[40:43], a[228:231], a[24:27], v[40:43]
ds_read_b128 a[208:211], v4 offset:18432
v_mfma_f32_16x16x32_bf16 v[60:63], a[228:231], a[28:31], v[60:63]
v_mfma_f32_16x16x32_bf16 v[44:47], a[232:235], a[24:27], v[44:47]
ds_read_b128 a[212:215], v4 offset:19456
v_mfma_f32_16x16x32_bf16 v[64:67], a[232:235], a[28:31], v[64:67]
v_mfma_f32_16x16x32_bf16 v[48:51], a[236:239], a[24:27], v[48:51]
ds_read_b128 a[216:219], v4 offset:20480
v_mfma_f32_16x16x32_bf16 v[68:71], a[236:239], a[28:31], v[68:71]
s_waitcnt vmcnt(10) lgkmcnt(0)
v_mfma_f32_16x16x32_bf16 v[32:35], a[200:203], a[32:35], v[32:35]
ds_read_b128 a[220:223], v4 offset:26624
v_mfma_f32_16x16x32_bf16 v[52:55], a[200:203], a[36:39], v[52:55]
v_mfma_f32_16x16x32_bf16 v[36:39], a[204:207], a[32:35], v[36:39]
ds_read_b128 a[224:227], v4 offset:27648
v_mfma_f32_16x16x32_bf16 v[56:59], a[204:207], a[36:39], v[56:59]
v_mfma_f32_16x16x32_bf16 v[40:43], a[208:211], a[32:35], v[40:43]
ds_read_b128 a[228:231], v4 offset:28672
v_mfma_f32_16x16x32_bf16 v[60:63], a[208:211], a[36:39], v[60:63]
v_mfma_f32_16x16x32_bf16 v[44:47], a[212:215], a[32:35], v[44:47]
ds_read_b128 a[232:235], v4 offset:29696
v_mfma_f32_16x16x32_bf16 v[64:67], a[212:215], a[36:39], v[64:67]
v_mfma_f32_16x16x32_bf16 v[48:51], a[216:219], a[32:35], v[48:51]
ds_read_b128 a[236:239], v4 offset:30720
v_mfma_f32_16x16x32_bf16 v[68:71], a[216:219], a[36:39], v[68:71]
s_waitcnt vmcnt(8) lgkmcnt(0)
v_mfma_f32_16x16x32_bf16 v[32:35], a[220:223], a[40:43], v[32:35]
ds_read_b128 a[200:203], v4 offset:36864
v_mfma_f32_16x16x32_bf16 v[52:55], a[220:223], a[44:47], v[52:55]
v_mfma_f32_16x16x32_bf16 v[36:39], a[224:227], a[40:43], v[36:39]
ds_read_b128 a[204:207], v4 offset:37888
v_mfma_f32_16x16x32_bf16 v[56:59], a[224:227], a[44:47], v[56:59]
v_mfma_f32_16x16x32_bf16 v[40:43], a[228:231], a[40:43], v[40:43]
ds_read_b128 a[208:211], v4 offset:38912
v_mfma_f32_16x16x32_bf16 v[60:63], a[228:231], a[44:47], v[60:63]
v_mfma_f32_16x16x32_bf16 v[44:47], a[232:235], a[40:43], v[44:47]
ds_read_b128 a[212:215], v4 offset:39936
v_mfma_f32_16x16x32_bf16 v[64:67], a[232:235], a[44:47], v[64:67]
v_mfma_f32_16x16x32_bf16 v[48:51], a[236:239], a[40:43], v[48:51]
ds_read_b128 a[216:219], v4 offset:40960
v_mfma_f32_16x16x32_bf16 v[68:71], a[236:239], a[44:47], v[68:71]
s_waitcnt vmcnt(6) lgkmcnt(0)
v_mfma_f32_16x16x32_bf16 v[32:35], a[200:203], a[48:51], v[32:35]
ds_read_b128 a[220:223], v4 offset:47104
v_mfma_f32_16x16x32_bf16 v[52:55], a[200:203], a[52:55], v[52:55]
v_mfma_f32_16x16x32_bf16 v[36:39], a[204:207], a[48:51], v[36:39]
ds_read_b128 a[224:227], v4 offset:48128
v_mfma_f32_16x16x32_bf16 v[56:59], a[204:207], a[52:55], v[56:59]
v_mfma_f32_16x16x32_bf16 v[40:43], a[208:211], a[48:51], v[40:43]
ds_read_b128 a[228:231], v4 offset:49152
v_mfma_f32_16x16x32_bf16 v[60:63], a[208:211], a[52:55], v[60:63]
v_mfma_f32_16x16x32_bf16 v[44:47], a[212:215], a[48:51], v[44:47]
ds_read_b128 a[232:235], v4 offset:50176
v_mfma_f32_16x16x32_bf16 v[64:67], a[212:215], a[52:55], v[64:67]
v_mfma_f32_16x16x32_bf16 v[48:51], a[216:219], a[48:51], v[48:51]
ds_read_b128 a[236:239], v4 offset:51200
v_mfma_f32_16x16x32_bf16 v[68:71], a[216:219], a[52:55], v[68:71]
s_waitcnt vmcnt(4) lgkmcnt(0)
v_mfma_f32_16x16x32_bf16 v[32:35], a[220:223], a[56:59], v[32:35]
ds_read_b128 a[200:203], v4 offset:57344
v_mfma_f32_16x16x32_bf16 v[52:55], a[220:223], a[60:63], v[52:55]
buffer_load_dword v235, v234, s[4:7], 0 offen sc1
v_mfma_f32_16x16x32_bf16 v[36:39], a[224:227], a[56:59], v[36:39]
ds_read_b128 a[204:207], v4 offset:58368
v_mfma_f32_16x16x32_bf16 v[56:59], a[224:227], a[60:63], v[56:59]
v_mfma_f32_16x16x32_bf16 v[40:43], a[228:231], a[56:59], v[40:43]
ds_read_b128 a[208:211], v4 offset:59392
v_mfma_f32_16x16x32_bf16 v[60:63], a[228:231], a[60:63], v[60:63]
v_mfma_f32_16x16x32_bf16 v[44:47], a[232:235], a[56:59], v[44:47]
ds_read_b128 a[212:215], v4 offset:60416
v_mfma_f32_16x16x32_bf16 v[64:67], a[232:235], a[60:63], v[64:67]
v_mfma_f32_16x16x32_bf16 v[48:51], a[236:239], a[56:59], v[48:51]
ds_read_b128 a[216:219], v5 offset:0
v_mfma_f32_16x16x32_bf16 v[68:71], a[236:239], a[60:63], v[68:71]
s_waitcnt vmcnt(3) lgkmcnt(0)
v_mfma_f32_16x16x32_bf16 v[32:35], a[200:203], a[64:67], v[32:35]
ds_read_b128 a[220:223], v5 offset:6144
v_mfma_f32_16x16x32_bf16 v[52:55], a[200:203], a[68:71], v[52:55]
v_mfma_f32_16x16x32_bf16 v[36:39], a[204:207], a[64:67], v[36:39]
ds_read_b128 a[224:227], v5 offset:7168
v_mfma_f32_16x16x32_bf16 v[56:59], a[204:207], a[68:71], v[56:59]
v_mfma_f32_16x16x32_bf16 v[40:43], a[208:211], a[64:67], v[40:43]
ds_read_b128 a[228:231], v5 offset:8192
v_mfma_f32_16x16x32_bf16 v[60:63], a[208:211], a[68:71], v[60:63]
v_mfma_f32_16x16x32_bf16 v[44:47], a[212:215], a[64:67], v[44:47]
ds_read_b128 a[232:235], v5 offset:9216
v_mfma_f32_16x16x32_bf16 v[64:67], a[212:215], a[68:71], v[64:67]
v_mfma_f32_16x16x32_bf16 v[48:51], a[216:219], a[64:67], v[48:51]
ds_read_b128 a[236:239], v5 offset:10240
v_mfma_f32_16x16x32_bf16 v[68:71], a[216:219], a[68:71], v[68:71]
s_waitcnt vmcnt(1) lgkmcnt(0)
v_mfma_f32_16x16x32_bf16 v[32:35], a[220:223], a[72:75], v[32:35]
v_mfma_f32_16x16x32_bf16 v[52:55], a[220:223], a[76:79], v[52:55]
v_mfma_f32_16x16x32_bf16 v[36:39], a[224:227], a[72:75], v[36:39]
v_mfma_f32_16x16x32_bf16 v[56:59], a[224:227], a[76:79], v[56:59]
v_mfma_f32_16x16x32_bf16 v[40:43], a[228:231], a[72:75], v[40:43]
v_mfma_f32_16x16x32_bf16 v[60:63], a[228:231], a[76:79], v[60:63]
v_mfma_f32_16x16x32_bf16 v[44:47], a[232:235], a[72:75], v[44:47]
v_mfma_f32_16x16x32_bf16 v[64:67], a[232:235], a[76:79], v[64:67]
v_mfma_f32_16x16x32_bf16 v[48:51], a[236:239], a[72:75], v[48:51]
v_mfma_f32_16x16x32_bf16 v[68:71], a[236:239], a[76:79], v[68:71]
ds_write_b128 v8, v[52:55] offset:0
s_nop 0
ds_write_b128 v8, v[56:59] offset:1024
s_nop 0
ds_write_b128 v8, v[60:63] offset:2048
s_nop 0
ds_write_b128 v8, v[64:67] offset:3072
s_nop 0
ds_write_b128 v8, v[68:71] offset:4096
s_waitcnt lgkmcnt(0)
s_barrier
ds_read_b128 v[52:55], v9 offset:0
ds_read_b128 v[56:59], v9 offset:1024
ds_read_b128 v[60:63], v9 offset:2048
ds_read_b128 v[64:67], v9 offset:3072
ds_read_b128 v[68:71], v9 offset:4096
s_waitcnt lgkmcnt(4)
v_pk_add_f32 v[32:33], v[32:33], v[52:53]
v_pk_add_f32 v[34:35], v[34:35], v[54:55]
s_waitcnt lgkmcnt(3)
v_pk_add_f32 v[36:37], v[36:37], v[56:57]
v_pk_add_f32 v[38:39], v[38:39], v[58:59]
s_waitcnt lgkmcnt(2)
v_pk_add_f32 v[40:41], v[40:41], v[60:61]
v_pk_add_f32 v[42:43], v[42:43], v[62:63]
s_waitcnt lgkmcnt(1)
v_pk_add_f32 v[44:45], v[44:45], v[64:65]
v_pk_add_f32 v[46:47], v[46:47], v[66:67]
s_waitcnt lgkmcnt(0)
v_pk_add_f32 v[48:49], v[48:49], v[68:69]
v_pk_add_f32 v[50:51], v[50:51], v[70:71]
v_lshlrev_b32 v10, 16, v82
v_and_b32 v11, 0xffff0000, v82
v_pk_add_f32 v[32:33], v[32:33], v[10:11]
v_cvt_pk_bf16_f32 v240, v32, v33
v_lshlrev_b32 v12, 16, v83
v_and_b32 v13, 0xffff0000, v83
v_pk_add_f32 v[34:35], v[34:35], v[12:13]
v_cvt_pk_bf16_f32 v241, v34, v35
v_lshlrev_b32 v10, 16, v84
v_and_b32 v11, 0xffff0000, v84
v_pk_add_f32 v[36:37], v[36:37], v[10:11]
v_cvt_pk_bf16_f32 v242, v36, v37
v_lshlrev_b32 v12, 16, v85
v_and_b32 v13, 0xffff0000, v85
v_pk_add_f32 v[38:39], v[38:39], v[12:13]
v_cvt_pk_bf16_f32 v243, v38, v39
v_lshlrev_b32 v10, 16, v86
v_and_b32 v11, 0xffff0000, v86
v_pk_add_f32 v[40:41], v[40:41], v[10:11]
v_cvt_pk_bf16_f32 v244, v40, v41
v_lshlrev_b32 v12, 16, v87
v_and_b32 v13, 0xffff0000, v87
v_pk_add_f32 v[42:43], v[42:43], v[12:13]
v_cvt_pk_bf16_f32 v245, v42, v43
v_lshlrev_b32 v10, 16, v88
v_and_b32 v11, 0xffff0000, v88
v_pk_add_f32 v[44:45], v[44:45], v[10:11]
v_cvt_pk_bf16_f32 v246, v44, v45
v_lshlrev_b32 v12, 16, v89
v_and_b32 v13, 0xffff0000, v89
v_pk_add_f32 v[46:47], v[46:47], v[12:13]
v_cvt_pk_bf16_f32 v247, v46, v47
v_lshlrev_b32 v10, 16, v90
v_and_b32 v11, 0xffff0000, v90
v_pk_add_f32 v[48:49], v[48:49], v[10:11]
v_cvt_pk_bf16_f32 v248, v48, v49
v_lshlrev_b32 v12, 16, v91
v_and_b32 v13, 0xffff0000, v91
v_pk_add_f32 v[50:51], v[50:51], v[12:13]
v_cvt_pk_bf16_f32 v249, v50, v51
s_add_u32 s37, s40, 4096
buffer_store_dwordx2 v[240:241], v232, s[4:7], s40 offen offset:0 sc1
buffer_store_dwordx2 v[242:243], v232, s[4:7], s40 offen offset:1024 sc1
buffer_store_dwordx2 v[244:245], v232, s[4:7], s40 offen offset:2048 sc1
buffer_store_dwordx2 v[246:247], v232, s[4:7], s40 offen offset:3072 sc1
buffer_store_dwordx2 v[248:249], v232, s[4:7], s37 offen offset:0 sc1
v_pk_mul_f32 v[16:17], v[32:33], v[32:33]
v_pk_add_f32 v[14:15], v[32:33], v[34:35]
v_pk_fma_f32 v[16:17], v[34:35], v[34:35], v[16:17]
v_pk_add_f32 v[14:15], v[14:15], v[36:37]
v_pk_fma_f32 v[16:17], v[36:37], v[36:37], v[16:17]
v_pk_add_f32 v[14:15], v[14:15], v[38:39]
v_pk_fma_f32 v[16:17], v[38:39], v[38:39], v[16:17]
v_pk_add_f32 v[14:15], v[14:15], v[40:41]
v_pk_fma_f32 v[16:17], v[40:41], v[40:41], v[16:17]
v_pk_add_f32 v[14:15], v[14:15], v[42:43]
v_pk_fma_f32 v[16:17], v[42:43], v[42:43], v[16:17]
v_pk_add_f32 v[14:15], v[14:15], v[44:45]
v_pk_fma_f32 v[16:17], v[44:45], v[44:45], v[16:17]
v_pk_add_f32 v[14:15], v[14:15], v[46:47]
v_pk_fma_f32 v[16:17], v[46:47], v[46:47], v[16:17]
v_pk_add_f32 v[14:15], v[14:15], v[48:49]
v_pk_fma_f32 v[16:17], v[48:49], v[48:49], v[16:17]
v_pk_add_f32 v[14:15], v[14:15], v[50:51]
v_pk_fma_f32 v[16:17], v[50:51], v[50:51], v[16:17]
v_add_f32 v14, v14, v15
v_add_f32 v15, v16, v17
v_mov_b32 v16, v14
v_mov_b32 v17, v15
s_nop 0
v_permlane32_swap_b32 v14, v16
v_permlane32_swap_b32 v15, v17
v_pk_add_f32 v[14:15], v[14:15], v[16:17]
v_mov_b32 v16, v14
v_mov_b32 v17, v15
s_nop 0
v_permlane16_swap_b32 v14, v16
v_permlane16_swap_b32 v15, v17
v_pk_add_f32 v[14:15], v[14:15], v[16:17]
buffer_store_dwordx2 v[14:15], v233, s[4:7], s41 offen sc1
s_waitcnt vmcnt(6)
s_add_u32 s3, s19, 16
v_cmp_ne_u32 vcc, s3, v235
s_nop 3
s_cmp_eq_u64 vcc, 0
s_cbranch_scc1 L_bgok_25
s_mov_b32 s69, s3
s_mov_b32 s3, 0
L_poll_bgslow_27:
buffer_load_dword v235, v234, s[4:7], 0 offen sc1
s_add_u32 s3, s3, 1
s_cmp_gt_u32 s3, 400000
s_cbranch_scc1 L_polld_bgslow_28
s_waitcnt vmcnt(0)
v_cmp_ne_u32 vcc, s69, v235
s_nop 3
s_cmp_eq_u64 vcc, 0
s_cbranch_scc0 L_poll_bgslow_27
L_polld_bgslow_28:
s_waitcnt vmcnt(0)
L_bgok_25:
s_or_b32 s3, s2, s16
s_cmp_lg_u32 s3, 0
s_cbranch_scc1 L_noep_26
v_mov_b32 v236, 0x0
v_mov_b32 v237, s19
s_mov_b64 exec, 1
buffer_store_dword v237, v236, s[4:7], 0 offen sc1
s_mov_b64 exec, -1
L_noep_26:
v_and_b32 v17, 31, v1
v_lshlrev_b32 v17, 5, v17
v_lshrrev_b32 v18, 5, v1
v_lshl_add_u32 v17, v18, 4, v17
s_mul_i32 s50, s18, 3072
s_add_u32 s50, s50, 0xeb8000
s_add_u32 s51, s50, 0
buffer_load_dwordx4 v[176:179], v17, s[4:7], s51 offen sc1
s_add_u32 s51, s50, 49152
buffer_load_dwordx4 v[180:183], v17, s[4:7], s51 offen sc1
s_add_u32 s51, s50, 1024
buffer_load_dwordx4 v[184:187], v17, s[4:7], s51 offen sc1
s_add_u32 s51, s50, 50176
buffer_load_dwordx4 v[188:191], v17, s[4:7], s51 offen sc1
s_add_u32 s51, s50, 2048
buffer_load_dwordx4 v[192:195], v17, s[4:7], s51 offen sc1
s_add_u32 s51, s50, 51200
buffer_load_dwordx4 v[196:199], v17, s[4:7], s51 offen sc1
s_add_u32 m0, s21, 139264
s_add_u32 s39, s22, 0
buffer_load_dwordx4 v2, s[4:7], s39 offen offset:0 sc1 lds
buffer_load_dwordx4 v2, s[4:7], s39 offen offset:1024 sc1 lds
buffer_load_dwordx4 v2, s[4:7], s39 offen offset:2048 sc1 lds
s_add_u32 m0, s21, 151552
s_add_u32 s39, s22, 12288
buffer_load_dwordx4 v2, s[4:7], s39 offen offset:0 sc1 lds
buffer_load_dwordx4 v2, s[4:7], s39 offen offset:1024 sc1 lds
buffer_load_dwordx4 v2, s[4:7], s39 offen offset:2048 sc1 lds
s_add_u32 m0, s21, 40960
s_add_u32 s39, s22, 24576
buffer_load_dwordx4 v2, s[4:7], s39 offen offset:0 sc1 lds
buffer_load_dwordx4 v2, s[4:7], s39 offen offset:1024 sc1 lds
buffer_load_dwordx4 v2, s[4:7], s39 offen offset:2048 sc1 lds
s_add_u32 m0, s21, 53248
s_add_u32 s39, s22, 36864
buffer_load_dwordx4 v2, s[4:7], s39 offen offset:0 sc1 lds
buffer_load_dwordx4 v2, s[4:7], s39 offen offset:1024 sc1 lds
buffer_load_dwordx4 v2, s[4:7], s39 offen offset:2048 sc1 lds
s_lshl_b32 s50, s17, 2
s_add_u32 s50, s50, s16
s_mul_i32 s20, s50, 40960
s_add_u32 s20, s20, 0x858000
v_and_b32 v8, 15, v1
v_lshlrev_b32 v8, 4, v8
v_bfe_u32 v9, v1, 4, 1
v_lshl_add_u32 v8, v9, 9, v8
v_lshrrev_b32 v9, 5, v1
v_mul_u32_u24 v10, 6144, v9
v_add_u32 v3, v8, v10
v_add_u32 v4, 61440, v3
v_add_u32 v5, 122880, v3
v_lshl_add_u32 v6, v9, 10, v8
v_add_u32 v7, 256, v6
v_and_b32 v8, 31, v1
v_lshlrev_b32 v233, 6, v8
s_lshl_b32 s50, s17, 7
s_lshl_b32 s51, s16, 5
s_add_u32 s50, s50, s51
s_lshl_b32 s50, s50, 6
s_add_u32 s43, s50, 0xad8000
s_lshl_b32 s50, s17, 3
s_lshl_b32 s51, s16, 1
s_add_u32 s50, s50, s51
s_mul_i32 s50, s50, 49152
s_lshr_b32 s51, s18, 3
s_mul_i32 s51, s51, 24
s_and_b32 s52, s18, 7
s_add_u32 s51, s51, s52
s_lshl_b32 s51, s51, 10
s_add_u32 s50, s50, s51
s_add_u32 s42, s50, 0xed0000
s_lshl_b32 s64, s16, 10
s_mul_i32 s65, s60, 245760
s_add_u32 s65, s65, 0x14d0000
s_add_u32 s65, s65, s64
s_barrier
s_cmp_lg_u32 s16, 0
s_cbranch_scc1 L_arr_29
s_lshl_b32 s3, s17, 7
s_add_u32 s3, s3, 0x3800
v_mov_b32 v14, s3
v_mov_b32 v15, 1
s_mov_b64 exec, 1
buffer_atomic_add v15, v14, s[4:7], 0 offen sc1
s_mov_b64 exec, -1
L_arr_29:
s_add_u32 m0, s21, 65536
s_add_u32 s39, s22, 49152
buffer_load_dwordx4 v2, s[4:7], s39 offen offset:0 sc1 lds
buffer_load_dwordx4 v2, s[4:7], s39 offen offset:1024 sc1 lds
buffer_load_dwordx4 v2, s[4:7], s39 offen offset:2048 sc1 lds
s_add_u32 m0, s21, 77824
s_add_u32 s39, s22, 61440
buffer_load_dwordx4 v2, s[4:7], s39 offen offset:0 sc1 lds
buffer_load_dwordx4 v2, s[4:7], s39 offen offset:1024 sc1 lds
buffer_load_dwordx4 v2, s[4:7], s39 offen offset:2048 sc1 lds
s_waitcnt vmcnt(18)
v_cmp_gt_u32 s[50:51], 16, v1
v_mov_b32 v12, 0
v_pk_add_f32 v[176:177], v[176:177], v[178:179]
v_pk_add_f32 v[180:181], v[180:181], v[182:183]
v_pk_add_f32 v[184:185], v[184:185], v[186:187]
v_pk_add_f32 v[188:189], v[188:189], v[190:191]
v_pk_add_f32 v[192:193], v[192:193], v[194:195]
v_pk_add_f32 v[196:197], v[196:197], v[198:199]
v_add_f32 v176, v176, v177
v_add_f32 v180, v180, v181
v_add_f32 v184, v184, v185
v_add_f32 v188, v188, v189
v_add_f32 v192, v192, v193
v_add_f32 v196, v196, v197
v_mov_b32 v177, v176
v_mov_b32 v181, v180
v_mov_b32 v185, v184
v_mov_b32 v189, v188
v_mov_b32 v193, v192
v_mov_b32 v197, v196
v_permlane32_swap_b32 v176, v177
v_permlane32_swap_b32 v180, v181
v_permlane32_swap_b32 v184, v185
v_permlane32_swap_b32 v188, v189
v_permlane32_swap_b32 v192, v193
v_permlane32_swap_b32 v196, v197
v_add_f32 v176, v176, v177
v_add_f32 v180, v180, v181
v_add_f32 v184, v184, v185
v_add_f32 v188, v188, v189
v_add_f32 v192, v192, v193
v_add_f32 v196, v196, v197
v_cvt_pk_bf16_f32 v177, v176, 0
v_cvt_pk_bf16_f32 v181, v180, 0
v_cvt_pk_bf16_f32 v185, v184, 0
v_cvt_pk_bf16_f32 v189, v188, 0
v_cvt_pk_bf16_f32 v193, v192, 0
v_cvt_pk_bf16_f32 v197, v196, 0
v_lshlrev_b32 v178, 16, v177
v_lshlrev_b32 v182, 16, v181
v_lshlrev_b32 v186, 16, v185
v_lshlrev_b32 v190, 16, v189
v_lshlrev_b32 v194, 16, v193
v_lshlrev_b32 v198, 16, v197
v_sub_f32 v178, v176, v178
v_sub_f32 v182, v180, v182
v_sub_f32 v186, v184, v186
v_sub_f32 v190, v188, v190
v_sub_f32 v194, v192, v194
v_sub_f32 v198, v196, v198
v_cvt_pk_bf16_f32 v176, v176, v178
v_cvt_pk_bf16_f32 v180, v180, v182
v_cvt_pk_bf16_f32 v184, v184, v186
v_cvt_pk_bf16_f32 v188, v188, v190
v_cvt_pk_bf16_f32 v192, v192, v194
v_cvt_pk_bf16_f32 v196, v196, v198
v_mov_b32 v177, v176
v_mov_b32 v181, v180
v_mov_b32 v185, v184
v_mov_b32 v189, v188
v_mov_b32 v193, v192
v_mov_b32 v197, v196
v_permlane16_swap_b32 v176, v177
v_permlane16_swap_b32 v180, v181
v_permlane16_swap_b32 v184, v185
v_permlane16_swap_b32 v188, v189
v_permlane16_swap_b32 v192, v193
v_permlane16_swap_b32 v196, v197
v_cndmask_b32 v176, v12, v176, s[50:51]
v_cndmask_b32 v180, v12, v180, s[50:51]
v_cndmask_b32 v184, v12, v184, s[50:51]
v_cndmask_b32 v188, v12, v188, s[50:51]
v_cndmask_b32 v192, v12, v192, s[50:51]
v_cndmask_b32 v196, v12, v196, s[50:51]
v_cndmask_b32 v177, v12, v177, s[50:51]
v_cndmask_b32 v181, v12, v181, s[50:51]
v_cndmask_b32 v185, v12, v185, s[50:51]
v_cndmask_b32 v189, v12, v189, s[50:51]
v_cndmask_b32 v193, v12, v193, s[50:51]
v_cndmask_b32 v197, v12, v197, s[50:51]
v_accvgpr_write_b32 a160, v176
v_accvgpr_write_b32 a168, v180
v_accvgpr_write_b32 a176, v184
v_accvgpr_write_b32 a184, v188
v_accvgpr_write_b32 a192, v192
v_accvgpr_write_b32 a200, v196
v_accvgpr_write_b32 a161, v176
v_accvgpr_write_b32 a169, v180
v_accvgpr_write_b32 a177, v184
v_accvgpr_write_b32 a185, v188
v_accvgpr_write_b32 a193, v192
v_accvgpr_write_b32 a201, v196
v_accvgpr_write_b32 a162, v12
v_accvgpr_write_b32 a170, v12
v_accvgpr_write_b32 a178, v12
v_accvgpr_write_b32 a186, v12
v_accvgpr_write_b32 a194, v12
v_accvgpr_write_b32 a202, v12
v_accvgpr_write_b32 a163, v12
v_accvgpr_write_b32 a171, v12
v_accvgpr_write_b32 a179, v12
v_accvgpr_write_b32 a187, v12
v_accvgpr_write_b32 a195, v12
v_accvgpr_write_b32 a203, v12
v_accvgpr_write_b32 a164, v177
v_accvgpr_write_b32 a172, v181
v_accvgpr_write_b32 a180, v185
v_accvgpr_write_b32 a188, v189
v_accvgpr_write_b32 a196, v193
v_accvgpr_write_b32 a204, v197
v_accvgpr_write_b32 a165, v177
v_accvgpr_write_b32 a173, v181
v_accvgpr_write_b32 a181, v185
v_accvgpr_write_b32 a189, v189
v_accvgpr_write_b32 a197, v193
v_accvgpr_write_b32 a205, v197
v_accvgpr_write_b32 a166, v12
v_accvgpr_write_b32 a174, v12
v_accvgpr_write_b32 a182, v12
v_accvgpr_write_b32 a190, v12
v_accvgpr_write_b32 a198, v12
v_accvgpr_write_b32 a206, v12
v_accvgpr_write_b32 a167, v12
v_accvgpr_write_b32 a175, v12
v_accvgpr_write_b32 a183, v12
v_accvgpr_write_b32 a191, v12
v_accvgpr_write_b32 a199, v12
v_accvgpr_write_b32 a207, v12
s_cmp_lg_u32 s16, 0
s_cbranch_scc1 L_wg_g2_30
s_lshl_b32 s3, s17, 7
s_add_u32 s3, s3, 0x3800
v_mov_b32 v14, s3
s_add_u32 s37, s19, 16
s_mov_b32 s3, 0
L_poll_g2_31:
buffer_load_dword v16, v14, s[4:7], 0 offen sc1
s_add_u32 s3, s3, 1
s_cmp_gt_u32 s3, 400000
s_cbranch_scc1 L_polld_g2_32
s_waitcnt vmcnt(0)
v_cmp_ne_u32 vcc, s37, v16
s_nop 3
s_cmp_eq_u64 vcc, 0
s_cbranch_scc0 L_poll_g2_31
L_polld_g2_32:
s_waitcnt vmcnt(0)
L_wg_g2_30:
s_barrier
s_add_u32 s38, s20, 0
buffer_load_dwordx4 a[0:3], v6, s[4:7], s38 offen offset:0 sc1
buffer_load_dwordx4 a[4:7], v7, s[4:7], s38 offen offset:0 sc1
buffer_load_dwordx4 a[8:11], v6, s[4:7], s38 offen offset:2048 sc1
buffer_load_dwordx4 a[12:15], v7, s[4:7], s38 offen offset:2048 sc1
s_add_u32 s38, s20, 4096
buffer_load_dwordx4 a[16:19], v6, s[4:7], s38 offen offset:0 sc1
buffer_load_dwordx4 a[20:23], v7, s[4:7], s38 offen offset:0 sc1
buffer_load_dwordx4 a[24:27], v6, s[4:7], s38 offen offset:2048 sc1
buffer_load_dwordx4 a[28:31], v7, s[4:7], s38 offen offset:2048 sc1
s_add_u32 s38, s20, 8192
buffer_load_dwordx4 a[32:35], v6, s[4:7], s38 offen offset:0 sc1
buffer_load_dwordx4 a[36:39], v7, s[4:7], s38 offen offset:0 sc1
s_barrier
ds_read_b128 v[128:131], v5 offset:16384
ds_read_b128 v[132:135], v5 offset:16640
ds_read_b128 v[136:139], v5 offset:17408
ds_read_b128 v[140:143], v5 offset:17664
ds_read_b128 v[144:147], v5 offset:18432
ds_read_b128 v[148:151], v5 offset:18688
ds_read_b128 v[152:155], v5 offset:19456
ds_read_b128 v[156:159], v5 offset:19712
ds_read_b128 v[160:163], v5 offset:20480
ds_read_b128 v[164:167], v5 offset:20736
ds_read_b128 v[168:171], v5 offset:21504
ds_read_b128 v[172:175], v5 offset:21760
s_waitcnt vmcnt(8)
s_barrier
s_waitcnt lgkmcnt(8)
v_mfma_f32_16x16x32_bf16 v[32:35], v[128:131], a[0:3], 0
v_mfma_f32_16x16x32_bf16 v[80:83], v[128:131], a[4:7], 0
v_mfma_f32_16x16x32_bf16 v[36:39], v[132:135], a[0:3], 0
ds_read_b128 v[128:131], v5 offset:28672
v_mfma_f32_16x16x32_bf16 v[84:87], v[132:135], a[4:7], 0
buffer_load_dwordx4 a[40:43], v6, s[4:7], s38 offen offset:2048 sc1
v_mfma_f32_16x16x32_bf16 v[40:43], v[136:139], a[0:3], 0
ds_read_b128 v[132:135], v5 offset:28928
v_mfma_f32_16x16x32_bf16 v[88:91], v[136:139], a[4:7], 0
v_mfma_f32_16x16x32_bf16 v[44:47], v[140:143], a[0:3], 0
ds_read_b128 v[136:139], v5 offset:29696
v_mfma_f32_16x16x32_bf16 v[92:95], v[140:143], a[4:7], 0
buffer_load_dwordx4 a[44:47], v7, s[4:7], s38 offen offset:2048 sc1
s_waitcnt lgkmcnt(7)
v_mfma_f32_16x16x32_bf16 v[48:51], v[144:147], a[0:3], 0
ds_read_b128 v[140:143], v5 offset:29952
v_mfma_f32_16x16x32_bf16 v[96:99], v[144:147], a[4:7], 0
v_mfma_f32_16x16x32_bf16 v[52:55], v[148:151], a[0:3], 0
ds_read_b128 v[144:147], v5 offset:30720
v_mfma_f32_16x16x32_bf16 v[100:103], v[148:151], a[4:7], 0
s_add_u32 m0, s21, 90112
s_add_u32 s39, s22, 73728
buffer_load_dwordx4 v2, s[4:7], s39 offen offset:0 sc1 lds
v_mfma_f32_16x16x32_bf16 v[56:59], v[152:155], a[0:3], 0
ds_read_b128 v[148:151], v5 offset:30976
v_mfma_f32_16x16x32_bf16 v[104:107], v[152:155], a[4:7], 0
v_mfma_f32_16x16x32_bf16 v[60:63], v[156:159], a[0:3], 0
ds_read_b128 v[152:155], v5 offset:31744
v_mfma_f32_16x16x32_bf16 v[108:111], v[156:159], a[4:7], 0
buffer_load_dwordx4 v2, s[4:7], s39 offen offset:1024 sc1 lds
s_waitcnt lgkmcnt(7)
v_mfma_f32_16x16x32_bf16 v[64:67], v[160:163], a[0:3], 0
ds_read_b128 v[156:159], v5 offset:32000
v_mfma_f32_16x16x32_bf16 v[112:115], v[160:163], a[4:7], 0
v_mfma_f32_16x16x32_bf16 v[68:71], v[164:167], a[0:3], 0
ds_read_b128 v[160:163], v5 offset:32768
v_mfma_f32_16x16x32_bf16 v[116:119], v[164:167], a[4:7], 0
buffer_load_dwordx4 v2, s[4:7], s39 offen offset:2048 sc1 lds
v_mfma_f32_16x16x32_bf16 v[72:75], v[168:171], a[0:3], 0
ds_read_b128 v[164:167], v5 offset:33024
v_mfma_f32_16x16x32_bf16 v[120:123], v[168:171], a[4:7], 0
v_mfma_f32_16x16x32_bf16 v[76:79], v[172:175], a[0:3], 0
ds_read_b128 v[168:171], v5 offset:33792
v_mfma_f32_16x16x32_bf16 v[124:127], v[172:175], a[4:7], 0
ds_read_b128 v[172:175], v5 offset:34048
s_waitcnt vmcnt(11)
s_barrier
s_waitcnt lgkmcnt(8)
v_mfma_f32_16x16x32_bf16 v[32:35], v[128:131], a[8:11], v[32:35]
v_mfma_f32_16x16x32_bf16 v[80:83], v[128:131], a[12:15], v[80:83]
v_mfma_f32_16x16x32_bf16 v[36:39], v[132:135], a[8:11], v[36:39]
ds_read_b128 v[128:131], v3 offset:40960
v_mfma_f32_16x16x32_bf16 v[84:87], v[132:135], a[12:15], v[84:87]
s_add_u32 s38, s20, 12288
buffer_load_dwordx4 a[48:51], v6, s[4:7], s38 offen offset:0 sc1
v_mfma_f32_16x16x32_bf16 v[40:43], v[136:139], a[8:11], v[40:43]
ds_read_b128 v[132:135], v3 offset:41216
v_mfma_f32_16x16x32_bf16 v[88:91], v[136:139], a[12:15], v[88:91]
v_mfma_f32_16x16x32_bf16 v[44:47], v[140:143], a[8:11], v[44:47]
ds_read_b128 v[136:139], v3 offset:41984
v_mfma_f32_16x16x32_bf16 v[92:95], v[140:143], a[12:15], v[92:95]
buffer_load_dwordx4 a[52:55], v7, s[4:7], s38 offen offset:0 sc1
s_waitcnt lgkmcnt(7)
v_mfma_f32_16x16x32_bf16 v[48:51], v[144:147], a[8:11], v[48:51]
ds_read_b128 v[140:143], v3 offset:42240
v_mfma_f32_16x16x32_bf16 v[96:99], v[144:147], a[12:15], v[96:99]
v_mfma_f32_16x16x32_bf16 v[52:55], v[148:151], a[8:11], v[52:55]
ds_read_b128 v[144:147], v3 offset:43008
v_mfma_f32_16x16x32_bf16 v[100:103], v[148:151], a[12:15], v[100:103]
s_add_u32 m0, s21, 102400
s_add_u32 s39, s22, 86016
buffer_load_dwordx4 v2, s[4:7], s39 offen offset:0 sc1 lds
v_mfma_f32_16x16x32_bf16 v[56:59], v[152:155], a[8:11], v[56:59]
ds_read_b128 v[148:151], v3 offset:43264
v_mfma_f32_16x16x32_bf16 v[104:107], v[152:155], a[12:15], v[104:107]
v_mfma_f32_16x16x32_bf16 v[60:63], v[156:159], a[8:11], v[60:63]
ds_read_b128 v[152:155], v3 offset:44032
v_mfma_f32_16x16x32_bf16 v[108:111], v[156:159], a[12:15], v[108:111]
buffer_load_dwordx4 v2, s[4:7], s39 offen offset:1024 sc1 lds
s_waitcnt lgkmcnt(7)
v_mfma_f32_16x16x32_bf16 v[64:67], v[160:163], a[8:11], v[64:67]
ds_read_b128 v[156:159], v3 offset:44288
v_mfma_f32_16x16x32_bf16 v[112:115], v[160:163], a[12:15], v[112:115]
v_mfma_f32_16x16x32_bf16 v[68:71], v[164:167], a[8:11], v[68:71]
ds_read_b128 v[160:163], v3 offset:45056
v_mfma_f32_16x16x32_bf16 v[116:119], v[164:167], a[12:15], v[116:119]
buffer_load_dwordx4 v2, s[4:7], s39 offen offset:2048 sc1 lds
v_mfma_f32_16x16x32_bf16 v[72:75], v[168:171], a[8:11], v[72:75]
ds_read_b128 v[164:167], v3 offset:45312
v_mfma_f32_16x16x32_bf16 v[120:123], v[168:171], a[12:15], v[120:123]
v_mfma_f32_16x16x32_bf16 v[76:79], v[172:175], a[8:11], v[76:79]
ds_read_b128 v[168:171], v3 offset:46080
v_mfma_f32_16x16x32_bf16 v[124:127], v[172:175], a[12:15], v[124:127]
ds_read_b128 v[172:175], v3 offset:46336
s_waitcnt vmcnt(14)
s_barrier
s_waitcnt lgkmcnt(8)
v_mfma_f32_16x16x32_bf16 v[32:35], v[128:131], a[16:19], v[32:35]
v_mfma_f32_16x16x32_bf16 v[80:83], v[128:131], a[20:23], v[80:83]
v_mfma_f32_16x16x32_bf16 v[36:39], v[132:135], a[16:19], v[36:39]
ds_read_b128 v[128:131], v3 offset:53248
v_mfma_f32_16x16x32_bf16 v[84:87], v[132:135], a[20:23], v[84:87]
buffer_load_dwordx4 a[56:59], v6, s[4:7], s38 offen offset:2048 sc1
v_mfma_f32_16x16x32_bf16 v[40:43], v[136:139], a[16:19], v[40:43]
ds_read_b128 v[132:135], v3 offset:53504
v_mfma_f32_16x16x32_bf16 v[88:91], v[136:139], a[20:23], v[88:91]
v_mfma_f32_16x16x32_bf16 v[44:47], v[140:143], a[16:19], v[44:47]
ds_read_b128 v[136:139], v3 offset:54272
v_mfma_f32_16x16x32_bf16 v[92:95], v[140:143], a[20:23], v[92:95]
buffer_load_dwordx4 a[60:63], v7, s[4:7], s38 offen offset:2048 sc1
s_waitcnt lgkmcnt(7)
v_mfma_f32_16x16x32_bf16 v[48:51], v[144:147], a[16:19], v[48:51]
ds_read_b128 v[140:143], v3 offset:54528
v_mfma_f32_16x16x32_bf16 v[96:99], v[144:147], a[20:23], v[96:99]
v_mfma_f32_16x16x32_bf16 v[52:55], v[148:151], a[16:19], v[52:55]
ds_read_b128 v[144:147], v3 offset:55296
v_mfma_f32_16x16x32_bf16 v[100:103], v[148:151], a[20:23], v[100:103]
s_add_u32 m0, s21, 114688
s_add_u32 s39, s22, 98304
buffer_load_dwordx4 v2, s[4:7], s39 offen offset:0 sc1 lds
v_mfma_f32_16x16x32_bf16 v[56:59], v[152:155], a[16:19], v[56:59]
ds_read_b128 v[148:151], v3 offset:55552
v_mfma_f32_16x16x32_bf16 v[104:107], v[152:155], a[20:23], v[104:107]
v_mfma_f32_16x16x32_bf16 v[60:63], v[156:159], a[16:19], v[60:63]
ds_read_b128 v[152:155], v3 offset:56320
v_mfma_f32_16x16x32_bf16 v[108:111], v[156:159], a[20:23], v[108:111]
buffer_load_dwordx4 v2, s[4:7], s39 offen offset:1024 sc1 lds
s_waitcnt lgkmcnt(7)
v_mfma_f32_16x16x32_bf16 v[64:67], v[160:163], a[16:19], v[64:67]
ds_read_b128 v[156:159], v3 offset:56576
v_mfma_f32_16x16x32_bf16 v[112:115], v[160:163], a[20:23], v[112:115]
v_mfma_f32_16x16x32_bf16 v[68:71], v[164:167], a[16:19], v[68:71]
ds_read_b128 v[160:163], v3 offset:57344
v_mfma_f32_16x16x32_bf16 v[116:119], v[164:167], a[20:23], v[116:119]
buffer_load_dwordx4 v2, s[4:7], s39 offen offset:2048 sc1 lds
v_mfma_f32_16x16x32_bf16 v[72:75], v[168:171], a[16:19], v[72:75]
ds_read_b128 v[164:167], v3 offset:57600
v_mfma_f32_16x16x32_bf16 v[120:123], v[168:171], a[20:23], v[120:123]
v_mfma_f32_16x16x32_bf16 v[76:79], v[172:175], a[16:19], v[76:79]
ds_read_b128 v[168:171], v3 offset:58368
v_mfma_f32_16x16x32_bf16 v[124:127], v[172:175], a[20:23], v[124:127]
ds_read_b128 v[172:175], v3 offset:58624
s_waitcnt vmcnt(17)
s_barrier
s_waitcnt lgkmcnt(8)
v_mfma_f32_16x16x32_bf16 v[32:35], v[128:131], a[24:27], v[32:35]
v_mfma_f32_16x16x32_bf16 v[80:83], v[128:131], a[28:31], v[80:83]
v_mfma_f32_16x16x32_bf16 v[36:39], v[132:135], a[24:27], v[36:39]
ds_read_b128 v[128:131], v4 offset:4096
v_mfma_f32_16x16x32_bf16 v[84:87], v[132:135], a[28:31], v[84:87]
s_add_u32 s38, s20, 16384
buffer_load_dwordx4 a[64:67], v6, s[4:7], s38 offen offset:0 sc1
v_mfma_f32_16x16x32_bf16 v[40:43], v[136:139], a[24:27], v[40:43]
ds_read_b128 v[132:135], v4 offset:4352
v_mfma_f32_16x16x32_bf16 v[88:91], v[136:139], a[28:31], v[88:91]
v_mfma_f32_16x16x32_bf16 v[44:47], v[140:143], a[24:27], v[44:47]
ds_read_b128 v[136:139], v4 offset:5120
v_mfma_f32_16x16x32_bf16 v[92:95], v[140:143], a[28:31], v[92:95]
buffer_load_dwordx4 a[68:71], v7, s[4:7], s38 offen offset:0 sc1
s_waitcnt lgkmcnt(7)
v_mfma_f32_16x16x32_bf16 v[48:51], v[144:147], a[24:27], v[48:51]
ds_read_b128 v[140:143], v4 offset:5376
v_mfma_f32_16x16x32_bf16 v[96:99], v[144:147], a[28:31], v[96:99]
v_mfma_f32_16x16x32_bf16 v[52:55], v[148:151], a[24:27], v[52:55]
ds_read_b128 v[144:147], v4 offset:6144
v_mfma_f32_16x16x32_bf16 v[100:103], v[148:151], a[28:31], v[100:103]
s_add_u32 m0, s21, 126976
s_add_u32 s39, s22, 110592
buffer_load_dwordx4 v2, s[4:7], s39 offen offset:0 sc1 lds
v_mfma_f32_16x16x32_bf16 v[56:59], v[152:155], a[24:27], v[56:59]
ds_read_b128 v[148:151], v4 offset:6400
v_mfma_f32_16x16x32_bf16 v[104:107], v[152:155], a[28:31], v[104:107]
v_mfma_f32_16x16x32_bf16 v[60:63], v[156:159], a[24:27], v[60:63]
ds_read_b128 v[152:155], v4 offset:7168
v_mfma_f32_16x16x32_bf16 v[108:111], v[156:159], a[28:31], v[108:111]
buffer_load_dwordx4 v2, s[4:7], s39 offen offset:1024 sc1 lds
s_waitcnt lgkmcnt(7)
v_mfma_f32_16x16x32_bf16 v[64:67], v[160:163], a[24:27], v[64:67]
ds_read_b128 v[156:159], v4 offset:7424
v_mfma_f32_16x16x32_bf16 v[112:115], v[160:163], a[28:31], v[112:115]
v_mfma_f32_16x16x32_bf16 v[68:71], v[164:167], a[24:27], v[68:71]
ds_read_b128 v[160:163], v4 offset:8192
v_mfma_f32_16x16x32_bf16 v[116:119], v[164:167], a[28:31], v[116:119]
buffer_load_dwordx4 v2, s[4:7], s39 offen offset:2048 sc1 lds
v_mfma_f32_16x16x32_bf16 v[72:75], v[168:171], a[24:27], v[72:75]
ds_read_b128 v[164:167], v4 offset:8448
v_mfma_f32_16x16x32_bf16 v[120:123], v[168:171], a[28:31], v[120:123]
v_mfma_f32_16x16x32_bf16 v[76:79], v[172:175], a[24:27], v[76:79]
ds_read_b128 v[168:171], v4 offset:9216
v_mfma_f32_16x16x32_bf16 v[124:127], v[172:175], a[28:31], v[124:127]
ds_read_b128 v[172:175], v4 offset:9472
s_waitcnt vmcnt(20)
s_barrier
s_waitcnt lgkmcnt(8)
v_mfma_f32_16x16x32_bf16 v[32:35], v[128:131], a[32:35], v[32:35]
v_mfma_f32_16x16x32_bf16 v[80:83], v[128:131], a[36:39], v[80:83]
v_mfma_f32_16x16x32_bf16 v[36:39], v[132:135], a[32:35], v[36:39]
ds_read_b128 v[128:131], v4 offset:16384
v_mfma_f32_16x16x32_bf16 v[84:87], v[132:135], a[36:39], v[84:87]
buffer_load_dwordx4 a[72:75], v6, s[4:7], s38 offen offset:2048 sc1
v_mfma_f32_16x16x32_bf16 v[40:43], v[136:139], a[32:35], v[40:43]
ds_read_b128 v[132:135], v4 offset:16640
v_mfma_f32_16x16x32_bf16 v[88:91], v[136:139], a[36:39], v[88:91]
v_mfma_f32_16x16x32_bf16 v[44:47], v[140:143], a[32:35], v[44:47]
ds_read_b128 v[136:139], v4 offset:17408
v_mfma_f32_16x16x32_bf16 v[92:95], v[140:143], a[36:39], v[92:95]
buffer_load_dwordx4 a[76:79], v7, s[4:7], s38 offen offset:2048 sc1
s_waitcnt lgkmcnt(7)
v_mfma_f32_16x16x32_bf16 v[48:51], v[144:147], a[32:35], v[48:51]
ds_read_b128 v[140:143], v4 offset:17664
v_mfma_f32_16x16x32_bf16 v[96:99], v[144:147], a[36:39], v[96:99]
v_mfma_f32_16x16x32_bf16 v[52:55], v[148:151], a[32:35], v[52:55]
ds_read_b128 v[144:147], v4 offset:18432
v_mfma_f32_16x16x32_bf16 v[100:103], v[148:151], a[36:39], v[100:103]
s_add_u32 m0, s21, 28672
s_add_u32 s39, s22, 122880
buffer_load_dwordx4 v2, s[4:7], s39 offen offset:0 sc1 lds
v_mfma_f32_16x16x32_bf16 v[56:59], v[152:155], a[32:35], v[56:59]
ds_read_b128 v[148:151], v4 offset:18688
v_mfma_f32_16x16x32_bf16 v[104:107], v[152:155], a[36:39], v[104:107]
v_mfma_f32_16x16x32_bf16 v[60:63], v[156:159], a[32:35], v[60:63]
ds_read_b128 v[152:155], v4 offset:19456
v_mfma_f32_16x16x32_bf16 v[108:111], v[156:159], a[36:39], v[108:111]
buffer_load_dwordx4 v2, s[4:7], s39 offen offset:1024 sc1 lds
s_waitcnt lgkmcnt(7)
v_mfma_f32_16x16x32_bf16 v[64:67], v[160:163], a[32:35], v[64:67]
ds_read_b128 v[156:159], v4 offset:19712
v_mfma_f32_16x16x32_bf16 v[112:115], v[160:163], a[36:39], v[112:115]
v_mfma_f32_16x16x32_bf16 v[68:71], v[164:167], a[32:35], v[68:71]
ds_read_b128 v[160:163], v4 offset:20480
v_mfma_f32_16x16x32_bf16 v[116:119], v[164:167], a[36:39], v[116:119]
buffer_load_dwordx4 v2, s[4:7], s39 offen offset:2048 sc1 lds
v_mfma_f32_16x16x32_bf16 v[72:75], v[168:171], a[32:35], v[72:75]
ds_read_b128 v[164:167], v4 offset:20736
v_mfma_f32_16x16x32_bf16 v[120:123], v[168:171], a[36:39], v[120:123]
v_mfma_f32_16x16x32_bf16 v[76:79], v[172:175], a[32:35], v[76:79]
ds_read_b128 v[168:171], v4 offset:21504
v_mfma_f32_16x16x32_bf16 v[124:127], v[172:175], a[36:39], v[124:127]
ds_read_b128 v[172:175], v4 offset:21760
s_waitcnt vmcnt(20)
s_barrier
s_waitcnt lgkmcnt(8)
v_mfma_f32_16x16x32_bf16 v[32:35], v[128:131], a[40:43], v[32:35]
v_mfma_f32_16x16x32_bf16 v[80:83], v[128:131], a[44:47], v[80:83]
v_mfma_f32_16x16x32_bf16 v[36:39], v[132:135], a[40:43], v[36:39]
ds_read_b128 v[128:131], v4 offset:28672
v_mfma_f32_16x16x32_bf16 v[84:87], v[132:135], a[44:47], v[84:87]
s_add_u32 s38, s20, 20480
buffer_load_dwordx4 a[80:83], v6, s[4:7], s38 offen offset:0 sc1
v_mfma_f32_16x16x32_bf16 v[40:43], v[136:139], a[40:43], v[40:43]
ds_read_b128 v[132:135], v4 offset:28928
v_mfma_f32_16x16x32_bf16 v[88:91], v[136:139], a[44:47], v[88:91]
v_mfma_f32_16x16x32_bf16 v[44:47], v[140:143], a[40:43], v[44:47]
ds_read_b128 v[136:139], v4 offset:29696
v_mfma_f32_16x16x32_bf16 v[92:95], v[140:143], a[44:47], v[92:95]
buffer_load_dwordx4 a[84:87], v7, s[4:7], s38 offen offset:0 sc1
s_waitcnt lgkmcnt(7)
v_mfma_f32_16x16x32_bf16 v[48:51], v[144:147], a[40:43], v[48:51]
ds_read_b128 v[140:143], v4 offset:29952
v_mfma_f32_16x16x32_bf16 v[96:99], v[144:147], a[44:47], v[96:99]
v_mfma_f32_16x16x32_bf16 v[52:55], v[148:151], a[40:43], v[52:55]
ds_read_b128 v[144:147], v4 offset:30720
v_mfma_f32_16x16x32_bf16 v[100:103], v[148:151], a[44:47], v[100:103]
s_add_u32 m0, s21, 4096
s_add_u32 s39, s22, 135168
buffer_load_dwordx4 v2, s[4:7], s39 offen offset:0 sc1 lds
v_mfma_f32_16x16x32_bf16 v[56:59], v[152:155], a[40:43], v[56:59]
ds_read_b128 v[148:151], v4 offset:30976
v_mfma_f32_16x16x32_bf16 v[104:107], v[152:155], a[44:47], v[104:107]
v_mfma_f32_16x16x32_bf16 v[60:63], v[156:159], a[40:43], v[60:63]
ds_read_b128 v[152:155], v4 offset:31744
v_mfma_f32_16x16x32_bf16 v[108:111], v[156:159], a[44:47], v[108:111]
buffer_load_dwordx4 v2, s[4:7], s39 offen offset:1024 sc1 lds
s_waitcnt lgkmcnt(7)
v_mfma_f32_16x16x32_bf16 v[64:67], v[160:163], a[40:43], v[64:67]
ds_read_b128 v[156:159], v4 offset:32000
v_mfma_f32_16x16x32_bf16 v[112:115], v[160:163], a[44:47], v[112:115]
v_mfma_f32_16x16x32_bf16 v[68:71], v[164:167], a[40:43], v[68:71]
ds_read_b128 v[160:163], v4 offset:32768
v_mfma_f32_16x16x32_bf16 v[116:119], v[164:167], a[44:47], v[116:119]
buffer_load_dwordx4 v2, s[4:7], s39 offen offset:2048 sc1 lds
v_mfma_f32_16x16x32_bf16 v[72:75], v[168:171], a[40:43], v[72:75]
ds_read_b128 v[164:167], v4 offset:33024
v_mfma_f32_16x16x32_bf16 v[120:123], v[168:171], a[44:47], v[120:123]
v_mfma_f32_16x16x32_bf16 v[76:79], v[172:175], a[40:43], v[76:79]
ds_read_b128 v[168:171], v4 offset:33792
v_mfma_f32_16x16x32_bf16 v[124:127], v[172:175], a[44:47], v[124:127]
ds_read_b128 v[172:175], v4 offset:34048
s_waitcnt vmcnt(20)
s_barrier
s_waitcnt lgkmcnt(8)
v_mfma_f32_16x16x32_bf16 v[32:35], v[128:131], a[48:51], v[32:35]
v_mfma_f32_16x16x32_bf16 v[80:83], v[128:131], a[52:55], v[80:83]
v_mfma_f32_16x16x32_bf16 v[36:39], v[132:135], a[48:51], v[36:39]
ds_read_b128 v[128:131], v4 offset:40960
v_mfma_f32_16x16x32_bf16 v[84:87], v[132:135], a[52:55], v[84:87]
buffer_load_dwordx4 a[88:91], v6, s[4:7], s38 offen offset:2048 sc1
v_mfma_f32_16x16x32_bf16 v[40:43], v[136:139], a[48:51], v[40:43]
ds_read_b128 v[132:135], v4 offset:41216
v_mfma_f32_16x16x32_bf16 v[88:91], v[136:139], a[52:55], v[88:91]
v_mfma_f32_16x16x32_bf16 v[44:47], v[140:143], a[48:51], v[44:47]
ds_read_b128 v[136:139], v4 offset:41984
v_mfma_f32_16x16x32_bf16 v[92:95], v[140:143], a[52:55], v[92:95]
buffer_load_dwordx4 a[92:95], v7, s[4:7], s38 offen offset:2048 sc1
s_waitcnt lgkmcnt(7)
v_mfma_f32_16x16x32_bf16 v[48:51], v[144:147], a[48:51], v[48:51]
ds_read_b128 v[140:143], v4 offset:42240
v_mfma_f32_16x16x32_bf16 v[96:99], v[144:147], a[52:55], v[96:99]
v_mfma_f32_16x16x32_bf16 v[52:55], v[148:151], a[48:51], v[52:55]
ds_read_b128 v[144:147], v4 offset:43008
v_mfma_f32_16x16x32_bf16 v[100:103], v[148:151], a[52:55], v[100:103]
s_add_u32 m0, s21, 16384
s_add_u32 s39, s22, 147456
buffer_load_dwordx4 v2, s[4:7], s39 offen offset:0 sc1 lds
v_mfma_f32_16x16x32_bf16 v[56:59], v[152:155], a[48:51], v[56:59]
ds_read_b128 v[148:151], v4 offset:43264
v_mfma_f32_16x16x32_bf16 v[104:107], v[152:155], a[52:55], v[104:107]
v_mfma_f32_16x16x32_bf16 v[60:63], v[156:159], a[48:51], v[60:63]
ds_read_b128 v[152:155], v4 offset:44032
v_mfma_f32_16x16x32_bf16 v[108:111], v[156:159], a[52:55], v[108:111]
buffer_load_dwordx4 v2, s[4:7], s39 offen offset:1024 sc1 lds
s_waitcnt lgkmcnt(7)
v_mfma_f32_16x16x32_bf16 v[64:67], v[160:163], a[48:51], v[64:67]
ds_read_b128 v[156:159], v4 offset:44288
v_mfma_f32_16x16x32_bf16 v[112:115], v[160:163], a[52:55], v[112:115]
v_mfma_f32_16x16x32_bf16 v[68:71], v[164:167], a[48:51], v[68:71]
ds_read_b128 v[160:163], v4 offset:45056
v_mfma_f32_16x16x32_bf16 v[116:119], v[164:167], a[52:55], v[116:119]
buffer_load_dwordx4 v2, s[4:7], s39 offen offset:2048 sc1 lds
v_mfma_f32_16x16x32_bf16 v[72:75], v[168:171], a[48:51], v[72:75]
ds_read_b128 v[164:167], v4 offset:45312
v_mfma_f32_16x16x32_bf16 v[120:123], v[168:171], a[52:55], v[120:123]
v_mfma_f32_16x16x32_bf16 v[76:79], v[172:175], a[48:51], v[76:79]
ds_read_b128 v[168:171], v4 offset:46080
v_mfma_f32_16x16x32_bf16 v[124:127], v[172:175], a[52:55], v[124:127]
ds_read_b128 v[172:175], v4 offset:46336
s_waitcnt vmcnt(20)
s_barrier
s_waitcnt lgkmcnt(8)
v_mfma_f32_16x16x32_bf16 v[32:35], v[128:131], a[56:59], v[32:35]
v_mfma_f32_16x16x32_bf16 v[80:83], v[128:131], a[60:63], v[80:83]
v_mfma_f32_16x16x32_bf16 v[36:39], v[132:135], a[56:59], v[36:39]
ds_read_b128 v[128:131], v4 offset:53248
v_mfma_f32_16x16x32_bf16 v[84:87], v[132:135], a[60:63], v[84:87]
s_add_u32 s38, s20, 24576
buffer_load_dwordx4 a[96:99], v6, s[4:7], s38 offen offset:0 sc1
v_mfma_f32_16x16x32_bf16 v[40:43], v[136:139], a[56:59], v[40:43]
ds_read_b128 v[132:135], v4 offset:53504
v_mfma_f32_16x16x32_bf16 v[88:91], v[136:139], a[60:63], v[88:91]
v_mfma_f32_16x16x32_bf16 v[44:47], v[140:143], a[56:59], v[44:47]
ds_read_b128 v[136:139], v4 offset:54272
v_mfma_f32_16x16x32_bf16 v[92:95], v[140:143], a[60:63], v[92:95]
buffer_load_dwordx4 a[100:103], v7, s[4:7], s38 offen offset:0 sc1
s_waitcnt lgkmcnt(7)
v_mfma_f32_16x16x32_bf16 v[48:51], v[144:147], a[56:59], v[48:51]
ds_read_b128 v[140:143], v4 offset:54528
v_mfma_f32_16x16x32_bf16 v[96:99], v[144:147], a[60:63], v[96:99]
v_mfma_f32_16x16x32_bf16 v[52:55], v[148:151], a[56:59], v[52:55]
ds_read_b128 v[144:147], v4 offset:55296
v_mfma_f32_16x16x32_bf16 v[100:103], v[148:151], a[60:63], v[100:103]
s_add_u32 m0, s21, 139264
s_add_u32 s39, s22, 159744
buffer_load_dwordx4 v2, s[4:7], s39 offen offset:0 sc1 lds
v_mfma_f32_16x16x32_bf16 v[56:59], v[152:155], a[56:59], v[56:59]
ds_read_b128 v[148:151], v4 offset:55552
v_mfma_f32_16x16x32_bf16 v[104:107], v[152:155], a[60:63], v[104:107]
v_mfma_f32_16x16x32_bf16 v[60:63], v[156:159], a[56:59], v[60:63]
ds_read_b128 v[152:155], v4 offset:56320
v_mfma_f32_16x16x32_bf16 v[108:111], v[156:159], a[60:63], v[108:111]
buffer_load_dwordx4 v2, s[4:7], s39 offen offset:1024 sc1 lds
s_waitcnt lgkmcnt(7)
v_mfma_f32_16x16x32_bf16 v[64:67], v[160:163], a[56:59], v[64:67]
ds_read_b128 v[156:159], v4 offset:56576
v_mfma_f32_16x16x32_bf16 v[112:115], v[160:163], a[60:63], v[112:115]
v_mfma_f32_16x16x32_bf16 v[68:71], v[164:167], a[56:59], v[68:71]
ds_read_b128 v[160:163], v4 offset:57344
v_mfma_f32_16x16x32_bf16 v[116:119], v[164:167], a[60:63], v[116:119]
buffer_load_dwordx4 v2, s[4:7], s39 offen offset:2048 sc1 lds
v_mfma_f32_16x16x32_bf16 v[72:75], v[168:171], a[56:59], v[72:75]
ds_read_b128 v[164:167], v4 offset:57600
v_mfma_f32_16x16x32_bf16 v[120:123], v[168:171], a[60:63], v[120:123]
v_mfma_f32_16x16x32_bf16 v[76:79], v[172:175], a[56:59], v[76:79]
ds_read_b128 v[168:171], v4 offset:58368
v_mfma_f32_16x16x32_bf16 v[124:127], v[172:175], a[60:63], v[124:127]
ds_read_b128 v[172:175], v4 offset:58624
s_waitcnt vmcnt(20)
s_barrier
s_waitcnt lgkmcnt(8)
v_mfma_f32_16x16x32_bf16 v[32:35], v[128:131], a[64:67], v[32:35]
v_mfma_f32_16x16x32_bf16 v[80:83], v[128:131], a[68:71], v[80:83]
v_mfma_f32_16x16x32_bf16 v[36:39], v[132:135], a[64:67], v[36:39]
ds_read_b128 v[128:131], v5 offset:4096
v_mfma_f32_16x16x32_bf16 v[84:87], v[132:135], a[68:71], v[84:87]
buffer_load_dwordx4 a[104:107], v6, s[4:7], s38 offen offset:2048 sc1
v_mfma_f32_16x16x32_bf16 v[40:43], v[136:139], a[64:67], v[40:43]
ds_read_b128 v[132:135], v5 offset:4352
v_mfma_f32_16x16x32_bf16 v[88:91], v[136:139], a[68:71], v[88:91]
v_mfma_f32_16x16x32_bf16 v[44:47], v[140:143], a[64:67], v[44:47]
ds_read_b128 v[136:139], v5 offset:5120
v_mfma_f32_16x16x32_bf16 v[92:95], v[140:143], a[68:71], v[92:95]
buffer_load_dwordx4 a[108:111], v7, s[4:7], s38 offen offset:2048 sc1
s_waitcnt lgkmcnt(7)
v_mfma_f32_16x16x32_bf16 v[48:51], v[144:147], a[64:67], v[48:51]
ds_read_b128 v[140:143], v5 offset:5376
v_mfma_f32_16x16x32_bf16 v[96:99], v[144:147], a[68:71], v[96:99]
v_mfma_f32_16x16x32_bf16 v[52:55], v[148:151], a[64:67], v[52:55]
ds_read_b128 v[144:147], v5 offset:6144
v_mfma_f32_16x16x32_bf16 v[100:103], v[148:151], a[68:71], v[100:103]
s_add_u32 m0, s21, 151552
s_add_u32 s39, s22, 172032
buffer_load_dwordx4 v2, s[4:7], s39 offen offset:0 sc1 lds
v_mfma_f32_16x16x32_bf16 v[56:59], v[152:155], a[64:67], v[56:59]
ds_read_b128 v[148:151], v5 offset:6400
v_mfma_f32_16x16x32_bf16 v[104:107], v[152:155], a[68:71], v[104:107]
v_mfma_f32_16x16x32_bf16 v[60:63], v[156:159], a[64:67], v[60:63]
ds_read_b128 v[152:155], v5 offset:7168
v_mfma_f32_16x16x32_bf16 v[108:111], v[156:159], a[68:71], v[108:111]
buffer_load_dwordx4 v2, s[4:7], s39 offen offset:1024 sc1 lds
s_waitcnt lgkmcnt(7)
v_mfma_f32_16x16x32_bf16 v[64:67], v[160:163], a[64:67], v[64:67]
ds_read_b128 v[156:159], v5 offset:7424
v_mfma_f32_16x16x32_bf16 v[112:115], v[160:163], a[68:71], v[112:115]
v_mfma_f32_16x16x32_bf16 v[68:71], v[164:167], a[64:67], v[68:71]
ds_read_b128 v[160:163], v5 offset:8192
v_mfma_f32_16x16x32_bf16 v[116:119], v[164:167], a[68:71], v[116:119]
buffer_load_dwordx4 v2, s[4:7], s39 offen offset:2048 sc1 lds
v_mfma_f32_16x16x32_bf16 v[72:75], v[168:171], a[64:67], v[72:75]
ds_read_b128 v[164:167], v5 offset:8448
v_mfma_f32_16x16x32_bf16 v[120:123], v[168:171], a[68:71], v[120:123]
v_mfma_f32_16x16x32_bf16 v[76:79], v[172:175], a[64:67], v[76:79]
ds_read_b128 v[168:171], v5 offset:9216
v_mfma_f32_16x16x32_bf16 v[124:127], v[172:175], a[68:71], v[124:127]
ds_read_b128 v[172:175], v5 offset:9472
s_waitcnt vmcnt(20)
s_barrier
s_waitcnt lgkmcnt(8)
v_mfma_f32_16x16x32_bf16 v[32:35], v[128:131], a[72:75], v[32:35]
v_mfma_f32_16x16x32_bf16 v[80:83], v[128:131], a[76:79], v[80:83]
v_mfma_f32_16x16x32_bf16 v[36:39], v[132:135], a[72:75], v[36:39]
ds_read_b128 v[128:131], v3 offset:28672
v_mfma_f32_16x16x32_bf16 v[84:87], v[132:135], a[76:79], v[84:87]
s_add_u32 s38, s20, 28672
buffer_load_dwordx4 a[112:115], v6, s[4:7], s38 offen offset:0 sc1
v_mfma_f32_16x16x32_bf16 v[40:43], v[136:139], a[72:75], v[40:43]
ds_read_b128 v[132:135], v3 offset:28928
v_mfma_f32_16x16x32_bf16 v[88:91], v[136:139], a[76:79], v[88:91]
v_mfma_f32_16x16x32_bf16 v[44:47], v[140:143], a[72:75], v[44:47]
ds_read_b128 v[136:139], v3 offset:29696
v_mfma_f32_16x16x32_bf16 v[92:95], v[140:143], a[76:79], v[92:95]
buffer_load_dwordx4 a[116:119], v7, s[4:7], s38 offen offset:0 sc1
s_waitcnt lgkmcnt(7)
v_mfma_f32_16x16x32_bf16 v[48:51], v[144:147], a[72:75], v[48:51]
ds_read_b128 v[140:143], v3 offset:29952
v_mfma_f32_16x16x32_bf16 v[96:99], v[144:147], a[76:79], v[96:99]
v_mfma_f32_16x16x32_bf16 v[52:55], v[148:151], a[72:75], v[52:55]
ds_read_b128 v[144:147], v3 offset:30720
v_mfma_f32_16x16x32_bf16 v[100:103], v[148:151], a[76:79], v[100:103]
s_add_u32 m0, s21, 40960
s_add_u32 s39, s22, 184320
buffer_load_dwordx4 v2, s[4:7], s39 offen offset:0 sc1 lds
v_mfma_f32_16x16x32_bf16 v[56:59], v[152:155], a[72:75], v[56:59]
ds_read_b128 v[148:151], v3 offset:30976
v_mfma_f32_16x16x32_bf16 v[104:107], v[152:155], a[76:79], v[104:107]
v_mfma_f32_16x16x32_bf16 v[60:63], v[156:159], a[72:75], v[60:63]
ds_read_b128 v[152:155], v3 offset:31744
v_mfma_f32_16x16x32_bf16 v[108:111], v[156:159], a[76:79], v[108:111]
buffer_load_dwordx4 v2, s[4:7], s39 offen offset:1024 sc1 lds
s_waitcnt lgkmcnt(7)
v_mfma_f32_16x16x32_bf16 v[64:67], v[160:163], a[72:75], v[64:67]
ds_read_b128 v[156:159], v3 offset:32000
v_mfma_f32_16x16x32_bf16 v[112:115], v[160:163], a[76:79], v[112:115]
v_mfma_f32_16x16x32_bf16 v[68:71], v[164:167], a[72:75], v[68:71]
ds_read_b128 v[160:163], v3 offset:32768
v_mfma_f32_16x16x32_bf16 v[116:119], v[164:167], a[76:79], v[116:119]
buffer_load_dwordx4 v2, s[4:7], s39 offen offset:2048 sc1 lds
v_mfma_f32_16x16x32_bf16 v[72:75], v[168:171], a[72:75], v[72:75]
ds_read_b128 v[164:167], v3 offset:33024
v_mfma_f32_16x16x32_bf16 v[120:123], v[168:171], a[76:79], v[120:123]
v_mfma_f32_16x16x32_bf16 v[76:79], v[172:175], a[72:75], v[76:79]
ds_read_b128 v[168:171], v3 offset:33792
v_mfma_f32_16x16x32_bf16 v[124:127], v[172:175], a[76:79], v[124:127]
ds_read_b128 v[172:175], v3 offset:34048
s_waitcnt vmcnt(20)
s_barrier
s_waitcnt lgkmcnt(8)
v_mfma_f32_16x16x32_bf16 v[32:35], v[128:131], a[80:83], v[32:35]
v_mfma_f32_16x16x32_bf16 v[80:83], v[128:131], a[84:87], v[80:83]
v_mfma_f32_16x16x32_bf16 v[36:39], v[132:135], a[80:83], v[36:39]
ds_read_b128 v[128:131], v3 offset:4096
v_mfma_f32_16x16x32_bf16 v[84:87], v[132:135], a[84:87], v[84:87]
buffer_load_dwordx4 a[120:123], v6, s[4:7], s38 offen offset:2048 sc1
v_mfma_f32_16x16x32_bf16 v[40:43], v[136:139], a[80:83], v[40:43]
ds_read_b128 v[132:135], v3 offset:4352
v_mfma_f32_16x16x32_bf16 v[88:91], v[136:139], a[84:87], v[88:91]
v_mfma_f32_16x16x32_bf16 v[44:47], v[140:143], a[80:83], v[44:47]
ds_read_b128 v[136:139], v3 offset:5120
v_mfma_f32_16x16x32_bf16 v[92:95], v[140:143], a[84:87], v[92:95]
buffer_load_dwordx4 a[124:127], v7, s[4:7], s38 offen offset:2048 sc1
s_waitcnt lgkmcnt(7)
v_mfma_f32_16x16x32_bf16 v[48:51], v[144:147], a[80:83], v[48:51]
ds_read_b128 v[140:143], v3 offset:5376
v_mfma_f32_16x16x32_bf16 v[96:99], v[144:147], a[84:87], v[96:99]
v_mfma_f32_16x16x32_bf16 v[52:55], v[148:151], a[80:83], v[52:55]
ds_read_b128 v[144:147], v3 offset:6144
v_mfma_f32_16x16x32_bf16 v[100:103], v[148:151], a[84:87], v[100:103]
s_add_u32 m0, s21, 53248
s_add_u32 s39, s22, 196608
buffer_load_dwordx4 v2, s[4:7], s39 offen offset:0 sc1 lds
v_mfma_f32_16x16x32_bf16 v[56:59], v[152:155], a[80:83], v[56:59]
ds_read_b128 v[148:151], v3 offset:6400
v_mfma_f32_16x16x32_bf16 v[104:107], v[152:155], a[84:87], v[104:107]
v_mfma_f32_16x16x32_bf16 v[60:63], v[156:159], a[80:83], v[60:63]
ds_read_b128 v[152:155], v3 offset:7168
v_mfma_f32_16x16x32_bf16 v[108:111], v[156:159], a[84:87], v[108:111]
buffer_load_dwordx4 v2, s[4:7], s39 offen offset:1024 sc1 lds
s_waitcnt lgkmcnt(7)
v_mfma_f32_16x16x32_bf16 v[64:67], v[160:163], a[80:83], v[64:67]
ds_read_b128 v[156:159], v3 offset:7424
v_mfma_f32_16x16x32_bf16 v[112:115], v[160:163], a[84:87], v[112:115]
v_mfma_f32_16x16x32_bf16 v[68:71], v[164:167], a[80:83], v[68:71]
ds_read_b128 v[160:163], v3 offset:8192
v_mfma_f32_16x16x32_bf16 v[116:119], v[164:167], a[84:87], v[116:119]
buffer_load_dwordx4 v2, s[4:7], s39 offen offset:2048 sc1 lds
v_mfma_f32_16x16x32_bf16 v[72:75], v[168:171], a[80:83], v[72:75]
ds_read_b128 v[164:167], v3 offset:8448
v_mfma_f32_16x16x32_bf16 v[120:123], v[168:171], a[84:87], v[120:123]
v_mfma_f32_16x16x32_bf16 v[76:79], v[172:175], a[80:83], v[76:79]
ds_read_b128 v[168:171], v3 offset:9216
v_mfma_f32_16x16x32_bf16 v[124:127], v[172:175], a[84:87], v[124:127]
ds_read_b128 v[172:175], v3 offset:9472
s_waitcnt vmcnt(20)
s_barrier
s_waitcnt lgkmcnt(8)
v_mfma_f32_16x16x32_bf16 v[32:35], v[128:131], a[88:91], v[32:35]
v_mfma_f32_16x16x32_bf16 v[80:83], v[128:131], a[92:95], v[80:83]
v_mfma_f32_16x16x32_bf16 v[36:39], v[132:135], a[88:91], v[36:39]
ds_read_b128 v[128:131], v3 offset:16384
v_mfma_f32_16x16x32_bf16 v[84:87], v[132:135], a[92:95], v[84:87]
s_add_u32 s38, s20, 32768
buffer_load_dwordx4 a[128:131], v6, s[4:7], s38 offen offset:0 sc1
v_mfma_f32_16x16x32_bf16 v[40:43], v[136:139], a[88:91], v[40:43]
ds_read_b128 v[132:135], v3 offset:16640
v_mfma_f32_16x16x32_bf16 v[88:91], v[136:139], a[92:95], v[88:91]
v_mfma_f32_16x16x32_bf16 v[44:47], v[140:143], a[88:91], v[44:47]
ds_read_b128 v[136:139], v3 offset:17408
v_mfma_f32_16x16x32_bf16 v[92:95], v[140:143], a[92:95], v[92:95]
buffer_load_dwordx4 a[132:135], v7, s[4:7], s38 offen offset:0 sc1
s_waitcnt lgkmcnt(7)
v_mfma_f32_16x16x32_bf16 v[48:51], v[144:147], a[88:91], v[48:51]
ds_read_b128 v[140:143], v3 offset:17664
v_mfma_f32_16x16x32_bf16 v[96:99], v[144:147], a[92:95], v[96:99]
v_mfma_f32_16x16x32_bf16 v[52:55], v[148:151], a[88:91], v[52:55]
ds_read_b128 v[144:147], v3 offset:18432
v_mfma_f32_16x16x32_bf16 v[100:103], v[148:151], a[92:95], v[100:103]
s_add_u32 m0, s21, 65536
s_add_u32 s39, s22, 208896
buffer_load_dwordx4 v2, s[4:7], s39 offen offset:0 sc1 lds
v_mfma_f32_16x16x32_bf16 v[56:59], v[152:155], a[88:91], v[56:59]
ds_read_b128 v[148:151], v3 offset:18688
v_mfma_f32_16x16x32_bf16 v[104:107], v[152:155], a[92:95], v[104:107]
v_mfma_f32_16x16x32_bf16 v[60:63], v[156:159], a[88:91], v[60:63]
ds_read_b128 v[152:155], v3 offset:19456
v_mfma_f32_16x16x32_bf16 v[108:111], v[156:159], a[92:95], v[108:111]
buffer_load_dwordx4 v2, s[4:7], s39 offen offset:1024 sc1 lds
s_waitcnt lgkmcnt(7)
v_mfma_f32_16x16x32_bf16 v[64:67], v[160:163], a[88:91], v[64:67]
ds_read_b128 v[156:159], v3 offset:19712
v_mfma_f32_16x16x32_bf16 v[112:115], v[160:163], a[92:95], v[112:115]
v_mfma_f32_16x16x32_bf16 v[68:71], v[164:167], a[88:91], v[68:71]
ds_read_b128 v[160:163], v3 offset:20480
v_mfma_f32_16x16x32_bf16 v[116:119], v[164:167], a[92:95], v[116:119]
buffer_load_dwordx4 v2, s[4:7], s39 offen offset:2048 sc1 lds
v_mfma_f32_16x16x32_bf16 v[72:75], v[168:171], a[88:91], v[72:75]
ds_read_b128 v[164:167], v3 offset:20736
v_mfma_f32_16x16x32_bf16 v[120:123], v[168:171], a[92:95], v[120:123]
v_mfma_f32_16x16x32_bf16 v[76:79], v[172:175], a[88:91], v[76:79]
ds_read_b128 v[168:171], v3 offset:21504
v_mfma_f32_16x16x32_bf16 v[124:127], v[172:175], a[92:95], v[124:127]
ds_read_b128 v[172:175], v3 offset:21760
s_waitcnt vmcnt(20)
s_barrier
s_waitcnt lgkmcnt(8)
v_mfma_f32_16x16x32_bf16 v[32:35], v[128:131], a[96:99], v[32:35]
v_mfma_f32_16x16x32_bf16 v[80:83], v[128:131], a[100:103], v[80:83]
buffer_load_dwordx4 a[136:139], v6, s[4:7], s38 offen offset:2048 sc1
v_mfma_f32_16x16x32_bf16 v[36:39], v[132:135], a[96:99], v[36:39]
ds_read_b128 v[128:131], v5 offset:16384
v_mfma_f32_16x16x32_bf16 v[84:87], v[132:135], a[100:103], v[84:87]
buffer_load_dwordx4 a[140:143], v7, s[4:7], s38 offen offset:2048 sc1
v_mfma_f32_16x16x32_bf16 v[40:43], v[136:139], a[96:99], v[40:43]
ds_read_b128 v[132:135], v5 offset:16640
v_mfma_f32_16x16x32_bf16 v[88:91], v[136:139], a[100:103], v[88:91]
s_add_u32 m0, s21, 77824
s_add_u32 s39, s22, 221184
buffer_load_dwordx4 v2, s[4:7], s39 offen offset:0 sc1 lds
v_mfma_f32_16x16x32_bf16 v[44:47], v[140:143], a[96:99], v[44:47]
ds_read_b128 v[136:139], v5 offset:17408
v_mfma_f32_16x16x32_bf16 v[92:95], v[140:143], a[100:103], v[92:95]
buffer_load_dwordx4 v2, s[4:7], s39 offen offset:1024 sc1 lds
s_waitcnt lgkmcnt(7)
v_mfma_f32_16x16x32_bf16 v[48:51], v[144:147], a[96:99], v[48:51]
ds_read_b128 v[140:143], v5 offset:17664
v_mfma_f32_16x16x32_bf16 v[96:99], v[144:147], a[100:103], v[96:99]
buffer_load_dwordx4 v2, s[4:7], s39 offen offset:2048 sc1 lds
v_mfma_f32_16x16x32_bf16 v[52:55], v[148:151], a[96:99], v[52:55]
ds_read_b128 v[144:147], v5 offset:18432
v_mfma_f32_16x16x32_bf16 v[100:103], v[148:151], a[100:103], v[100:103]
buffer_load_dwordx4 v[216:219], v233, s[4:7], s43 offen offset:0 sc1
v_mfma_f32_16x16x32_bf16 v[56:59], v[152:155], a[96:99], v[56:59]
ds_read_b128 v[148:151], v5 offset:18688
v_mfma_f32_16x16x32_bf16 v[104:107], v[152:155], a[100:103], v[104:107]
v_mfma_f32_16x16x32_bf16 v[60:63], v[156:159], a[96:99], v[60:63]
ds_read_b128 v[152:155], v5 offset:19456
v_mfma_f32_16x16x32_bf16 v[108:111], v[156:159], a[100:103], v[108:111]
buffer_load_dwordx4 v[220:223], v233, s[4:7], s43 offen offset:16 sc1
s_waitcnt lgkmcnt(7)
v_mfma_f32_16x16x32_bf16 v[64:67], v[160:163], a[96:99], v[64:67]
ds_read_b128 v[156:159], v5 offset:19712
v_mfma_f32_16x16x32_bf16 v[112:115], v[160:163], a[100:103], v[112:115]
v_mfma_f32_16x16x32_bf16 v[68:71], v[164:167], a[96:99], v[68:71]
ds_read_b128 v[160:163], v5 offset:20480
v_mfma_f32_16x16x32_bf16 v[116:119], v[164:167], a[100:103], v[116:119]
buffer_load_dwordx4 v[224:227], v233, s[4:7], s43 offen offset:32 sc1
v_mfma_f32_16x16x32_bf16 v[72:75], v[168:171], a[96:99], v[72:75]
ds_read_b128 v[164:167], v5 offset:20736
v_mfma_f32_16x16x32_bf16 v[120:123], v[168:171], a[100:103], v[120:123]
v_mfma_f32_16x16x32_bf16 v[76:79], v[172:175], a[96:99], v[76:79]
ds_read_b128 v[168:171], v5 offset:21504
v_mfma_f32_16x16x32_bf16 v[124:127], v[172:175], a[100:103], v[124:127]
buffer_load_dwordx4 v[228:231], v233, s[4:7], s43 offen offset:48 sc1
ds_read_b128 v[172:175], v5 offset:21760
s_waitcnt vmcnt(24)
s_barrier
s_waitcnt lgkmcnt(8)
v_mfma_f32_16x16x32_bf16 v[32:35], v[128:131], a[104:107], v[32:35]
v_mfma_f32_16x16x32_bf16 v[80:83], v[128:131], a[108:111], v[80:83]
v_mfma_f32_16x16x32_bf16 v[36:39], v[132:135], a[104:107], v[36:39]
ds_read_b128 v[128:131], v5 offset:28672
v_mfma_f32_16x16x32_bf16 v[84:87], v[132:135], a[108:111], v[84:87]
s_add_u32 s38, s20, 36864
buffer_load_dwordx4 a[144:147], v6, s[4:7], s38 offen offset:0 sc1
v_mfma_f32_16x16x32_bf16 v[40:43], v[136:139], a[104:107], v[40:43]
ds_read_b128 v[132:135], v5 offset:28928
v_mfma_f32_16x16x32_bf16 v[88:91], v[136:139], a[108:111], v[88:91]
v_mfma_f32_16x16x32_bf16 v[44:47], v[140:143], a[104:107], v[44:47]
ds_read_b128 v[136:139], v5 offset:29696
v_mfma_f32_16x16x32_bf16 v[92:95], v[140:143], a[108:111], v[92:95]
buffer_load_dwordx4 a[148:151], v7, s[4:7], s38 offen offset:0 sc1
s_waitcnt lgkmcnt(7)
v_mfma_f32_16x16x32_bf16 v[48:51], v[144:147], a[104:107], v[48:51]
ds_read_b128 v[140:143], v5 offset:29952
v_mfma_f32_16x16x32_bf16 v[96:99], v[144:147], a[108:111], v[96:99]
v_mfma_f32_16x16x32_bf16 v[52:55], v[148:151], a[104:107], v[52:55]
ds_read_b128 v[144:147], v5 offset:30720
v_mfma_f32_16x16x32_bf16 v[100:103], v[148:151], a[108:111], v[100:103]
s_add_u32 m0, s21, 90112
s_add_u32 s39, s22, 233472
buffer_load_dwordx4 v2, s[4:7], s39 offen offset:0 sc1 lds
v_mfma_f32_16x16x32_bf16 v[56:59], v[152:155], a[104:107], v[56:59]
ds_read_b128 v[148:151], v5 offset:30976
v_mfma_f32_16x16x32_bf16 v[104:107], v[152:155], a[108:111], v[104:107]
v_mfma_f32_16x16x32_bf16 v[60:63], v[156:159], a[104:107], v[60:63]
ds_read_b128 v[152:155], v5 offset:31744
v_mfma_f32_16x16x32_bf16 v[108:111], v[156:159], a[108:111], v[108:111]
buffer_load_dwordx4 v2, s[4:7], s39 offen offset:1024 sc1 lds
s_waitcnt lgkmcnt(7)
v_mfma_f32_16x16x32_bf16 v[64:67], v[160:163], a[104:107], v[64:67]
ds_read_b128 v[156:159], v5 offset:32000
v_mfma_f32_16x16x32_bf16 v[112:115], v[160:163], a[108:111], v[112:115]
v_mfma_f32_16x16x32_bf16 v[68:71], v[164:167], a[104:107], v[68:71]
ds_read_b128 v[160:163], v5 offset:32768
v_mfma_f32_16x16x32_bf16 v[116:119], v[164:167], a[108:111], v[116:119]
buffer_load_dwordx4 v2, s[4:7], s39 offen offset:2048 sc1 lds
v_mfma_f32_16x16x32_bf16 v[72:75], v[168:171], a[104:107], v[72:75]
ds_read_b128 v[164:167], v5 offset:33024
v_mfma_f32_16x16x32_bf16 v[120:123], v[168:171], a[108:111], v[120:123]
v_mfma_f32_16x16x32_bf16 v[76:79], v[172:175], a[104:107], v[76:79]
ds_read_b128 v[168:171], v5 offset:33792
v_mfma_f32_16x16x32_bf16 v[124:127], v[172:175], a[108:111], v[124:127]
ds_read_b128 v[172:175], v5 offset:34048
s_waitcnt vmcnt(24)
s_barrier
s_waitcnt lgkmcnt(8)
v_mfma_f32_16x16x32_bf16 v[32:35], v[128:131], a[112:115], v[32:35]
v_mfma_f32_16x16x32_bf16 v[80:83], v[128:131], a[116:119], v[80:83]
v_mfma_f32_16x16x32_bf16 v[36:39], v[132:135], a[112:115], v[36:39]
ds_read_b128 v[128:131], v3 offset:40960
v_mfma_f32_16x16x32_bf16 v[84:87], v[132:135], a[116:119], v[84:87]
buffer_load_dwordx4 a[152:155], v6, s[4:7], s38 offen offset:2048 sc1
v_mfma_f32_16x16x32_bf16 v[40:43], v[136:139], a[112:115], v[40:43]
ds_read_b128 v[132:135], v3 offset:41216
v_mfma_f32_16x16x32_bf16 v[88:91], v[136:139], a[116:119], v[88:91]
v_mfma_f32_16x16x32_bf16 v[44:47], v[140:143], a[112:115], v[44:47]
ds_read_b128 v[136:139], v3 offset:41984
v_mfma_f32_16x16x32_bf16 v[92:95], v[140:143], a[116:119], v[92:95]
buffer_load_dwordx4 a[156:159], v7, s[4:7], s38 offen offset:2048 sc1
s_waitcnt lgkmcnt(7)
v_mfma_f32_16x16x32_bf16 v[48:51], v[144:147], a[112:115], v[48:51]
ds_read_b128 v[140:143], v3 offset:42240
v_mfma_f32_16x16x32_bf16 v[96:99], v[144:147], a[116:119], v[96:99]
v_mfma_f32_16x16x32_bf16 v[52:55], v[148:151], a[112:115], v[52:55]
ds_read_b128 v[144:147], v3 offset:43008
v_mfma_f32_16x16x32_bf16 v[100:103], v[148:151], a[116:119], v[100:103]
s_add_u32 m0, s64, 102400
s_add_u32 s37, s65, 0
buffer_load_dwordx4 v2, s[4:7], s37 offen sc1 lds
v_mfma_f32_16x16x32_bf16 v[56:59], v[152:155], a[112:115], v[56:59]
ds_read_b128 v[148:151], v3 offset:43264
v_mfma_f32_16x16x32_bf16 v[104:107], v[152:155], a[116:119], v[104:107]
v_mfma_f32_16x16x32_bf16 v[60:63], v[156:159], a[112:115], v[60:63]
ds_read_b128 v[152:155], v3 offset:44032
v_mfma_f32_16x16x32_bf16 v[108:111], v[156:159], a[116:119], v[108:111]
s_add_u32 m0, s64, 106496
s_add_u32 s37, s65, 4096
buffer_load_dwordx4 v2, s[4:7], s37 offen sc1 lds
s_waitcnt lgkmcnt(7)
v_mfma_f32_16x16x32_bf16 v[64:67], v[160:163], a[112:115], v[64:67]
ds_read_b128 v[156:159], v3 offset:44288
v_mfma_f32_16x16x32_bf16 v[112:115], v[160:163], a[116:119], v[112:115]
v_mfma_f32_16x16x32_bf16 v[68:71], v[164:167], a[112:115], v[68:71]
ds_read_b128 v[160:163], v3 offset:45056
v_mfma_f32_16x16x32_bf16 v[116:119], v[164:167], a[116:119], v[116:119]
s_add_u32 m0, s64, 110592
s_add_u32 s37, s65, 8192
buffer_load_dwordx4 v2, s[4:7], s37 offen sc1 lds
v_mfma_f32_16x16x32_bf16 v[72:75], v[168:171], a[112:115], v[72:75]
ds_read_b128 v[164:167], v3 offset:45312
v_mfma_f32_16x16x32_bf16 v[120:123], v[168:171], a[116:119], v[120:123]
v_mfma_f32_16x16x32_bf16 v[76:79], v[172:175], a[112:115], v[76:79]
ds_read_b128 v[168:171], v3 offset:46080
v_mfma_f32_16x16x32_bf16 v[124:127], v[172:175], a[116:119], v[124:127]
ds_read_b128 v[172:175], v3 offset:46336
s_waitcnt vmcnt(24)
s_barrier
s_waitcnt lgkmcnt(8)
v_mfma_f32_16x16x32_bf16 v[32:35], v[128:131], a[120:123], v[32:35]
v_mfma_f32_16x16x32_bf16 v[80:83], v[128:131], a[124:127], v[80:83]
s_waitcnt vmcnt(10)
v_pk_add_f32 v[216:217], v[216:217], v[218:219]
v_mfma_f32_16x16x32_bf16 v[36:39], v[132:135], a[120:123], v[36:39]
ds_read_b128 v[128:131], v3 offset:53248
v_mfma_f32_16x16x32_bf16 v[84:87], v[132:135], a[124:127], v[84:87]
s_add_u32 m0, s64, 114688
s_add_u32 s37, s65, 12288
buffer_load_dwordx4 v2, s[4:7], s37 offen sc1 lds
v_mfma_f32_16x16x32_bf16 v[40:43], v[136:139], a[120:123], v[40:43]
ds_read_b128 v[132:135], v3 offset:53504
v_mfma_f32_16x16x32_bf16 v[88:91], v[136:139], a[124:127], v[88:91]
v_pk_add_f32 v[220:221], v[220:221], v[222:223]
v_mfma_f32_16x16x32_bf16 v[44:47], v[140:143], a[120:123], v[44:47]
ds_read_b128 v[136:139], v3 offset:54272
v_mfma_f32_16x16x32_bf16 v[92:95], v[140:143], a[124:127], v[92:95]
s_add_u32 m0, s64, 118784
s_add_u32 s37, s65, 16384
buffer_load_dwordx4 v2, s[4:7], s37 offen sc1 lds
s_waitcnt lgkmcnt(7)
v_mfma_f32_16x16x32_bf16 v[48:51], v[144:147], a[120:123], v[48:51]
ds_read_b128 v[140:143], v3 offset:54528
v_mfma_f32_16x16x32_bf16 v[96:99], v[144:147], a[124:127], v[96:99]
v_pk_add_f32 v[224:225], v[224:225], v[226:227]
v_mfma_f32_16x16x32_bf16 v[52:55], v[148:151], a[120:123], v[52:55]
ds_read_b128 v[144:147], v3 offset:55296
v_mfma_f32_16x16x32_bf16 v[100:103], v[148:151], a[124:127], v[100:103]
s_add_u32 m0, s64, 0
s_add_u32 s37, s65, 20480
buffer_load_dwordx4 v2, s[4:7], s37 offen sc1 lds
v_mfma_f32_16x16x32_bf16 v[56:59], v[152:155], a[120:123], v[56:59]
ds_read_b128 v[148:151], v3 offset:55552
v_mfma_f32_16x16x32_bf16 v[104:107], v[152:155], a[124:127], v[104:107]
v_pk_add_f32 v[228:229], v[228:229], v[230:231]
v_mfma_f32_16x16x32_bf16 v[60:63], v[156:159], a[120:123], v[60:63]
ds_read_b128 v[152:155], v3 offset:56320
v_mfma_f32_16x16x32_bf16 v[108:111], v[156:159], a[124:127], v[108:111]
s_add_u32 m0, s64, 4096
s_add_u32 s37, s65, 24576
buffer_load_dwordx4 v2, s[4:7], s37 offen sc1 lds
s_waitcnt lgkmcnt(7)
v_mfma_f32_16x16x32_bf16 v[64:67], v[160:163], a[120:123], v[64:67]
ds_read_b128 v[156:159], v3 offset:56576
v_mfma_f32_16x16x32_bf16 v[112:115], v[160:163], a[124:127], v[112:115]
v_pk_add_f32 v[216:217], v[216:217], v[220:221]
v_mfma_f32_16x16x32_bf16 v[68:71], v[164:167], a[120:123], v[68:71]
ds_read_b128 v[160:163], v3 offset:57344
v_mfma_f32_16x16x32_bf16 v[116:119], v[164:167], a[124:127], v[116:119]
s_add_u32 m0, s64, 8192
s_add_u32 s37, s65, 28672
buffer_load_dwordx4 v2, s[4:7], s37 offen sc1 lds
v_mfma_f32_16x16x32_bf16 v[72:75], v[168:171], a[120:123], v[72:75]
ds_read_b128 v[164:167], v3 offset:57600
v_mfma_f32_16x16x32_bf16 v[120:123], v[168:171], a[124:127], v[120:123]
v_pk_add_f32 v[224:225], v[224:225], v[228:229]
v_mfma_f32_16x16x32_bf16 v[76:79], v[172:175], a[120:123], v[76:79]
ds_read_b128 v[168:171], v3 offset:58368
v_mfma_f32_16x16x32_bf16 v[124:127], v[172:175], a[124:127], v[124:127]
v_pk_add_f32 v[216:217], v[216:217], v[224:225]
ds_read_b128 v[172:175], v3 offset:58624
s_barrier
s_waitcnt lgkmcnt(8)
v_mfma_f32_16x16x32_bf16 v[32:35], v[128:131], a[128:131], v[32:35]
v_mfma_f32_16x16x32_bf16 v[80:83], v[128:131], a[132:135], v[80:83]
v_mul_f32 v216, 0x3acccccd, v216
v_mfma_f32_16x16x32_bf16 v[36:39], v[132:135], a[128:131], v[36:39]
ds_read_b128 v[128:131], v4 offset:4096
v_mfma_f32_16x16x32_bf16 v[84:87], v[132:135], a[132:135], v[84:87]
s_add_u32 m0, s64, 12288
s_add_u32 s37, s65, 32768
buffer_load_dwordx4 v2, s[4:7], s37 offen sc1 lds
v_mfma_f32_16x16x32_bf16 v[40:43], v[136:139], a[128:131], v[40:43]
ds_read_b128 v[132:135], v4 offset:4352
v_mfma_f32_16x16x32_bf16 v[88:91], v[136:139], a[132:135], v[88:91]
v_mul_f32 v217, 0x3acccccd, v217
v_mfma_f32_16x16x32_bf16 v[44:47], v[140:143], a[128:131], v[44:47]
ds_read_b128 v[136:139], v4 offset:5120
v_mfma_f32_16x16x32_bf16 v[92:95], v[140:143], a[132:135], v[92:95]
s_add_u32 m0, s64, 16384
s_add_u32 s37, s65, 36864
buffer_load_dwordx4 v2, s[4:7], s37 offen sc1 lds
s_waitcnt lgkmcnt(7)
v_mfma_f32_16x16x32_bf16 v[48:51], v[144:147], a[128:131], v[48:51]
ds_read_b128 v[140:143], v4 offset:5376
v_mfma_f32_16x16x32_bf16 v[96:99], v[144:147], a[132:135], v[96:99]
v_fma_f32 v217, -v216, v216, v217
v_mfma_f32_16x16x32_bf16 v[52:55], v[148:151], a[128:131], v[52:55]
ds_read_b128 v[144:147], v4 offset:6144
v_mfma_f32_16x16x32_bf16 v[100:103], v[148:151], a[132:135], v[100:103]
s_add_u32 m0, s64, 20480
s_add_u32 s37, s65, 40960
buffer_load_dwordx4 v2, s[4:7], s37 offen sc1 lds
v_mfma_f32_16x16x32_bf16 v[56:59], v[152:155], a[128:131], v[56:59]
ds_read_b128 v[148:151], v4 offset:6400
v_mfma_f32_16x16x32_bf16 v[104:107], v[152:155], a[132:135], v[104:107]
v_max_f32 v217, 0, v217
v_mfma_f32_16x16x32_bf16 v[60:63], v[156:159], a[128:131], v[60:63]
ds_read_b128 v[152:155], v4 offset:7168
v_mfma_f32_16x16x32_bf16 v[108:111], v[156:159], a[132:135], v[108:111]
s_add_u32 m0, s64, 24576
s_add_u32 s37, s65, 45056
buffer_load_dwordx4 v2, s[4:7], s37 offen sc1 lds
s_waitcnt lgkmcnt(7)
v_mfma_f32_16x16x32_bf16 v[64:67], v[160:163], a[128:131], v[64:67]
ds_read_b128 v[156:159], v4 offset:7424
v_mfma_f32_16x16x32_bf16 v[112:115], v[160:163], a[132:135], v[112:115]
v_add_f32 v217, 0x3727c5ac, v217
v_mfma_f32_16x16x32_bf16 v[68:71], v[164:167], a[128:131], v[68:71]
ds_read_b128 v[160:163], v4 offset:8192
v_mfma_f32_16x16x32_bf16 v[116:119], v[164:167], a[132:135], v[116:119]
s_add_u32 m0, s64, 28672
s_add_u32 s37, s65, 49152
buffer_load_dwordx4 v2, s[4:7], s37 offen sc1 lds
v_mfma_f32_16x16x32_bf16 v[72:75], v[168:171], a[128:131], v[72:75]
ds_read_b128 v[164:167], v4 offset:8448
v_mfma_f32_16x16x32_bf16 v[120:123], v[168:171], a[132:135], v[120:123]
v_rsq_f32 v218, v217
v_mfma_f32_16x16x32_bf16 v[76:79], v[172:175], a[128:131], v[76:79]
ds_read_b128 v[168:171], v4 offset:9216
v_mfma_f32_16x16x32_bf16 v[124:127], v[172:175], a[132:135], v[124:127]
v_sqrt_f32 v212, v217
ds_read_b128 v[172:175], v4 offset:9472
s_barrier
s_waitcnt lgkmcnt(8)
v_mfma_f32_16x16x32_bf16 v[32:35], v[128:131], a[136:139], v[32:35]
v_mfma_f32_16x16x32_bf16 v[80:83], v[128:131], a[140:143], v[80:83]
v_sub_f32 v216, 0, v216
v_mfma_f32_16x16x32_bf16 v[36:39], v[132:135], a[136:139], v[36:39]
ds_read_b128 v[128:131], v4 offset:16384
v_mfma_f32_16x16x32_bf16 v[84:87], v[132:135], a[140:143], v[84:87]
s_add_u32 m0, s64, 32768
s_add_u32 s37, s65, 53248
buffer_load_dwordx4 v2, s[4:7], s37 offen sc1 lds
v_mfma_f32_16x16x32_bf16 v[40:43], v[136:139], a[136:139], v[40:43]
ds_read_b128 v[132:135], v4 offset:16640
v_mfma_f32_16x16x32_bf16 v[88:91], v[136:139], a[140:143], v[88:91]
v_mul_f32 v208, 0xbfb8aa3b, v218
v_mfma_f32_16x16x32_bf16 v[44:47], v[140:143], a[136:139], v[44:47]
ds_read_b128 v[136:139], v4 offset:17408
v_mfma_f32_16x16x32_bf16 v[92:95], v[140:143], a[140:143], v[92:95]
s_add_u32 m0, s64, 36864
s_add_u32 s37, s65, 57344
buffer_load_dwordx4 v2, s[4:7], s37 offen sc1 lds
s_waitcnt lgkmcnt(7)
v_mfma_f32_16x16x32_bf16 v[48:51], v[144:147], a[136:139], v[48:51]
ds_read_b128 v[140:143], v4 offset:17664
v_mfma_f32_16x16x32_bf16 v[96:99], v[144:147], a[140:143], v[96:99]
v_cvt_pk_bf16_f32 v200, v216, v216
v_mfma_f32_16x16x32_bf16 v[52:55], v[148:151], a[136:139], v[52:55]
ds_read_b128 v[144:147], v4 offset:18432
v_mfma_f32_16x16x32_bf16 v[100:103], v[148:151], a[140:143], v[100:103]
s_add_u32 m0, s64, 122880
s_add_u32 s37, s65, 61440
buffer_load_dwordx4 v2, s[4:7], s37 offen sc1 lds
v_mfma_f32_16x16x32_bf16 v[56:59], v[152:155], a[136:139], v[56:59]
ds_read_b128 v[148:151], v4 offset:18688
v_mfma_f32_16x16x32_bf16 v[104:107], v[152:155], a[140:143], v[104:107]
v_and_b32 v219, 0xffff0000, v200
v_mfma_f32_16x16x32_bf16 v[60:63], v[156:159], a[136:139], v[60:63]
ds_read_b128 v[152:155], v4 offset:19456
v_mfma_f32_16x16x32_bf16 v[108:111], v[156:159], a[140:143], v[108:111]
s_add_u32 m0, s64, 126976
s_add_u32 s37, s65, 65536
buffer_load_dwordx4 v2, s[4:7], s37 offen sc1 lds
s_waitcnt lgkmcnt(7)
v_mfma_f32_16x16x32_bf16 v[64:67], v[160:163], a[136:139], v[64:67]
ds_read_b128 v[156:159], v4 offset:19712
v_mfma_f32_16x16x32_bf16 v[112:115], v[160:163], a[140:143], v[112:115]
v_sub_f32 v219, v216, v219
v_mfma_f32_16x16x32_bf16 v[68:71], v[164:167], a[136:139], v[68:71]
ds_read_b128 v[160:163], v4 offset:20480
v_mfma_f32_16x16x32_bf16 v[116:119], v[164:167], a[140:143], v[116:119]
s_add_u32 m0, s64, 131072
s_add_u32 s37, s65, 69632
buffer_load_dwordx4 v2, s[4:7], s37 offen sc1 lds
v_mfma_f32_16x16x32_bf16 v[72:75], v[168:171], a[136:139], v[72:75]
ds_read_b128 v[164:167], v4 offset:20736
v_mfma_f32_16x16x32_bf16 v[120:123], v[168:171], a[140:143], v[120:123]
v_cvt_pk_bf16_f32 v201, v219, v219
v_mfma_f32_16x16x32_bf16 v[76:79], v[172:175], a[136:139], v[76:79]
ds_read_b128 v[168:171], v4 offset:21504
v_mfma_f32_16x16x32_bf16 v[124:127], v[172:175], a[140:143], v[124:127]
v_mov_b32 v214, v212
ds_read_b128 v[172:175], v4 offset:21760
s_waitcnt vmcnt(20)
s_barrier
s_waitcnt lgkmcnt(8)
v_mfma_f32_16x16x32_bf16 v[32:35], v[128:131], a[144:147], v[32:35]
v_mfma_f32_16x16x32_bf16 v[80:83], v[128:131], a[148:151], v[80:83]
v_mov_b32 v210, v208
v_mfma_f32_16x16x32_bf16 v[36:39], v[132:135], a[144:147], v[36:39]
ds_read_b128 v[128:131], v4 offset:28672
v_mfma_f32_16x16x32_bf16 v[84:87], v[132:135], a[148:151], v[84:87]
s_add_u32 m0, s64, 135168
s_add_u32 s37, s65, 73728
buffer_load_dwordx4 v2, s[4:7], s37 offen sc1 lds
v_mfma_f32_16x16x32_bf16 v[40:43], v[136:139], a[144:147], v[40:43]
ds_read_b128 v[132:135], v4 offset:28928
v_mfma_f32_16x16x32_bf16 v[88:91], v[136:139], a[148:151], v[88:91]
v_mov_b32 v204, v200
v_mfma_f32_16x16x32_bf16 v[44:47], v[140:143], a[144:147], v[44:47]
ds_read_b128 v[136:139], v4 offset:29696
v_mfma_f32_16x16x32_bf16 v[92:95], v[140:143], a[148:151], v[92:95]
s_add_u32 m0, s64, 139264
s_add_u32 s37, s65, 77824
buffer_load_dwordx4 v2, s[4:7], s37 offen sc1 lds
s_waitcnt lgkmcnt(7)
v_mfma_f32_16x16x32_bf16 v[48:51], v[144:147], a[144:147], v[48:51]
ds_read_b128 v[140:143], v4 offset:29952
v_mfma_f32_16x16x32_bf16 v[96:99], v[144:147], a[148:151], v[96:99]
v_mov_b32 v205, v201
v_mfma_f32_16x16x32_bf16 v[52:55], v[148:151], a[144:147], v[52:55]
ds_read_b128 v[144:147], v4 offset:30720
v_mfma_f32_16x16x32_bf16 v[100:103], v[148:151], a[148:151], v[100:103]
s_add_u32 m0, s64, 143360
s_add_u32 s37, s65, 81920
buffer_load_dwordx4 v2, s[4:7], s37 offen sc1 lds
v_mfma_f32_16x16x32_bf16 v[56:59], v[152:155], a[144:147], v[56:59]
ds_read_b128 v[148:151], v4 offset:30976
v_mfma_f32_16x16x32_bf16 v[104:107], v[152:155], a[148:151], v[104:107]
v_mov_b32 v202, 0
v_mfma_f32_16x16x32_bf16 v[60:63], v[156:159], a[144:147], v[60:63]
ds_read_b128 v[152:155], v4 offset:31744
v_mfma_f32_16x16x32_bf16 v[108:111], v[156:159], a[148:151], v[108:111]
s_add_u32 m0, s64, 147456
s_add_u32 s37, s65, 86016
buffer_load_dwordx4 v2, s[4:7], s37 offen sc1 lds
s_waitcnt lgkmcnt(7)
v_mfma_f32_16x16x32_bf16 v[64:67], v[160:163], a[144:147], v[64:67]
ds_read_b128 v[156:159], v4 offset:32000
v_mfma_f32_16x16x32_bf16 v[112:115], v[160:163], a[148:151], v[112:115]
v_permlane16_swap_b32 v212, v214
v_mfma_f32_16x16x32_bf16 v[68:71], v[164:167], a[144:147], v[68:71]
ds_read_b128 v[160:163], v4 offset:32768
v_mfma_f32_16x16x32_bf16 v[116:119], v[164:167], a[148:151], v[116:119]
s_add_u32 m0, s64, 151552
s_add_u32 s37, s65, 90112
buffer_load_dwordx4 v2, s[4:7], s37 offen sc1 lds
v_mfma_f32_16x16x32_bf16 v[72:75], v[168:171], a[144:147], v[72:75]
ds_read_b128 v[164:167], v4 offset:33024
v_mfma_f32_16x16x32_bf16 v[120:123], v[168:171], a[148:151], v[120:123]
v_permlane16_swap_b32 v208, v210
v_mfma_f32_16x16x32_bf16 v[76:79], v[172:175], a[144:147], v[76:79]
ds_read_b128 v[168:171], v4 offset:33792
v_mfma_f32_16x16x32_bf16 v[124:127], v[172:175], a[148:151], v[124:127]
v_permlane16_swap_b32 v200, v204
ds_read_b128 v[172:175], v4 offset:34048
s_waitcnt vmcnt(23)
s_barrier
s_waitcnt lgkmcnt(8)
v_mfma_f32_16x16x32_bf16 v[32:35], v[128:131], a[152:155], v[32:35]
v_mfma_f32_16x16x32_bf16 v[80:83], v[128:131], a[156:159], v[80:83]
v_permlane16_swap_b32 v201, v205
v_mfma_f32_16x16x32_bf16 v[36:39], v[132:135], a[152:155], v[36:39]
v_mfma_f32_16x16x32_bf16 v[84:87], v[132:135], a[156:159], v[84:87]
s_add_u32 m0, s64, 155648
s_add_u32 s37, s65, 94208
buffer_load_dwordx4 v2, s[4:7], s37 offen sc1 lds
v_mfma_f32_16x16x32_bf16 v[40:43], v[136:139], a[152:155], v[40:43]
v_mfma_f32_16x16x32_bf16 v[88:91], v[136:139], a[156:159], v[88:91]
v_mov_b32 v203, 0
v_mfma_f32_16x16x32_bf16 v[44:47], v[140:143], a[152:155], v[44:47]
v_mfma_f32_16x16x32_bf16 v[92:95], v[140:143], a[156:159], v[92:95]
s_add_u32 m0, s64, 159744
s_add_u32 s37, s65, 98304
buffer_load_dwordx4 v2, s[4:7], s37 offen sc1 lds
s_waitcnt lgkmcnt(4)
v_mfma_f32_16x16x32_bf16 v[48:51], v[144:147], a[152:155], v[48:51]
v_mfma_f32_16x16x32_bf16 v[96:99], v[144:147], a[156:159], v[96:99]
v_mov_b32 v206, 0
v_mfma_f32_16x16x32_bf16 v[52:55], v[148:151], a[152:155], v[52:55]
v_mfma_f32_16x16x32_bf16 v[100:103], v[148:151], a[156:159], v[100:103]
s_add_u32 m0, s64, 40960
s_add_u32 s37, s65, 102400
buffer_load_dwordx4 v2, s[4:7], s37 offen sc1 lds
v_mfma_f32_16x16x32_bf16 v[56:59], v[152:155], a[152:155], v[56:59]
v_mfma_f32_16x16x32_bf16 v[104:107], v[152:155], a[156:159], v[104:107]
v_mov_b32 v207, 0
v_mfma_f32_16x16x32_bf16 v[60:63], v[156:159], a[152:155], v[60:63]
v_mfma_f32_16x16x32_bf16 v[108:111], v[156:159], a[156:159], v[108:111]
s_add_u32 m0, s64, 45056
s_add_u32 s37, s65, 106496
buffer_load_dwordx4 v2, s[4:7], s37 offen sc1 lds
s_waitcnt lgkmcnt(0)
v_mfma_f32_16x16x32_bf16 v[64:67], v[160:163], a[152:155], v[64:67]
v_mfma_f32_16x16x32_bf16 v[112:115], v[160:163], a[156:159], v[112:115]
v_mfma_f32_16x16x32_bf16 v[68:71], v[164:167], a[152:155], v[68:71]
v_mfma_f32_16x16x32_bf16 v[116:119], v[164:167], a[156:159], v[116:119]
s_add_u32 m0, s64, 49152
s_add_u32 s37, s65, 110592
buffer_load_dwordx4 v2, s[4:7], s37 offen sc1 lds
v_mfma_f32_16x16x32_bf16 v[72:75], v[168:171], a[152:155], v[72:75]
v_mfma_f32_16x16x32_bf16 v[120:123], v[168:171], a[156:159], v[120:123]
v_mfma_f32_16x16x32_bf16 v[76:79], v[172:175], a[152:155], v[76:79]
v_mfma_f32_16x16x32_bf16 v[124:127], v[172:175], a[156:159], v[124:127]
v_mfma_f32_16x16x32_bf16 v[32:35], a[160:163], v[200:203], v[32:35]
v_mfma_f32_16x16x32_bf16 v[80:83], a[160:163], v[204:207], v[80:83]
v_mfma_f32_16x16x32_bf16 v[36:39], a[164:167], v[200:203], v[36:39]
v_mfma_f32_16x16x32_bf16 v[84:87], a[164:167], v[204:207], v[84:87]
v_mfma_f32_16x16x32_bf16 v[40:43], a[168:171], v[200:203], v[40:43]
v_mfma_f32_16x16x32_bf16 v[88:91], a[168:171], v[204:207], v[88:91]
v_mfma_f32_16x16x32_bf16 v[44:47], a[172:175], v[200:203], v[44:47]
v_mfma_f32_16x16x32_bf16 v[92:95], a[172:175], v[204:207], v[92:95]
v_mfma_f32_16x16x32_bf16 v[48:51], a[176:179], v[200:203], v[48:51]
v_mfma_f32_16x16x32_bf16 v[96:99], a[176:179], v[204:207], v[96:99]
v_mfma_f32_16x16x32_bf16 v[52:55], a[180:183], v[200:203], v[52:55]
v_mfma_f32_16x16x32_bf16 v[100:103], a[180:183], v[204:207], v[100:103]
v_mfma_f32_16x16x32_bf16 v[56:59], a[184:187], v[200:203], v[56:59]
v_mfma_f32_16x16x32_bf16 v[104:107], a[184:187], v[204:207], v[104:107]
v_mfma_f32_16x16x32_bf16 v[60:63], a[188:191], v[200:203], v[60:63]
v_mfma_f32_16x16x32_bf16 v[108:111], a[188:191], v[204:207], v[108:111]
v_mfma_f32_16x16x32_bf16 v[64:67], a[192:195], v[200:203], v[64:67]
v_mfma_f32_16x16x32_bf16 v[112:115], a[192:195], v[204:207], v[112:115]
v_mfma_f32_16x16x32_bf16 v[68:71], a[196:199], v[200:203], v[68:71]
v_mfma_f32_16x16x32_bf16 v[116:119], a[196:199], v[204:207], v[116:119]
v_mfma_f32_16x16x32_bf16 v[72:75], a[200:203], v[200:203], v[72:75]
v_mfma_f32_16x16x32_bf16 v[120:123], a[200:203], v[204:207], v[120:123]
v_mfma_f32_16x16x32_bf16 v[76:79], a[204:207], v[200:203], v[76:79]
v_mfma_f32_16x16x32_bf16 v[124:127], a[204:207], v[204:207], v[124:127]
s_barrier
v_pk_mul_f32 v[32:33], v[32:33], v[208:209] op_sel_hi:[1,0]
v_pk_mul_f32 v[36:37], v[36:37], v[208:209] op_sel_hi:[1,0]
v_pk_mul_f32 v[80:81], v[80:81], v[210:211] op_sel_hi:[1,0]
v_pk_mul_f32 v[84:85], v[84:85], v[210:211] op_sel_hi:[1,0]
v_exp_f32 v32, v32
v_exp_f32 v36, v36
v_exp_f32 v80, v80
v_exp_f32 v84, v84
v_exp_f32 v33, v33
v_exp_f32 v37, v37
v_exp_f32 v81, v81
v_exp_f32 v85, v85
s_add_u32 m0, s64, 53248
s_add_u32 s37, s65, 114688
buffer_load_dwordx4 v2, s[4:7], s37 offen sc1 lds
v_pk_fma_f32 v[32:33], v[32:33], v[212:213], v[212:213] op_sel_hi:[1,0,0]
v_pk_fma_f32 v[36:37], v[36:37], v[212:213], v[212:213] op_sel_hi:[1,0,0]
v_pk_fma_f32 v[80:81], v[80:81], v[214:215], v[214:215] op_sel_hi:[1,0,0]
v_pk_fma_f32 v[84:85], v[84:85], v[214:215], v[214:215] op_sel_hi:[1,0,0]
v_rcp_f32 v32, v32
v_rcp_f32 v36, v36
v_rcp_f32 v80, v80
v_rcp_f32 v84, v84
v_rcp_f32 v33, v33
v_rcp_f32 v37, v37
v_rcp_f32 v81, v81
v_rcp_f32 v85, v85
s_add_u32 m0, s64, 57344
s_add_u32 s37, s65, 118784
buffer_load_dwordx4 v2, s[4:7], s37 offen sc1 lds
v_pk_mul_f32 v[40:41], v[40:41], v[32:33]
v_pk_mul_f32 v[44:45], v[44:45], v[36:37]
v_pk_mul_f32 v[88:89], v[88:89], v[80:81]
v_pk_mul_f32 v[92:93], v[92:93], v[84:85]
v_pk_mul_f32 v[34:35], v[34:35], v[208:209] op_sel_hi:[1,0]
v_pk_mul_f32 v[38:39], v[38:39], v[208:209] op_sel_hi:[1,0]
v_pk_mul_f32 v[82:83], v[82:83], v[210:211] op_sel_hi:[1,0]
v_pk_mul_f32 v[86:87], v[86:87], v[210:211] op_sel_hi:[1,0]
v_exp_f32 v34, v34
v_exp_f32 v38, v38
v_exp_f32 v82, v82
v_exp_f32 v86, v86
s_add_u32 m0, s64, 61440
s_add_u32 s37, s65, 122880
buffer_load_dwordx4 v2, s[4:7], s37 offen sc1 lds
v_exp_f32 v35, v35
v_exp_f32 v39, v39
v_exp_f32 v83, v83
v_exp_f32 v87, v87
v_pk_fma_f32 v[34:35], v[34:35], v[212:213], v[212:213] op_sel_hi:[1,0,0]
v_pk_fma_f32 v[38:39], v[38:39], v[212:213], v[212:213] op_sel_hi:[1,0,0]
v_pk_fma_f32 v[82:83], v[82:83], v[214:215], v[214:215] op_sel_hi:[1,0,0]
v_pk_fma_f32 v[86:87], v[86:87], v[214:215], v[214:215] op_sel_hi:[1,0,0]
v_rcp_f32 v34, v34
v_rcp_f32 v38, v38
v_rcp_f32 v82, v82
v_rcp_f32 v86, v86
s_add_u32 m0, s64, 65536
s_add_u32 s37, s65, 126976
buffer_load_dwordx4 v2, s[4:7], s37 offen sc1 lds
v_rcp_f32 v35, v35
v_rcp_f32 v39, v39
v_rcp_f32 v83, v83
v_rcp_f32 v87, v87
v_pk_mul_f32 v[42:43], v[42:43], v[34:35]
v_pk_mul_f32 v[46:47], v[46:47], v[38:39]
v_pk_mul_f32 v[90:91], v[90:91], v[82:83]
v_pk_mul_f32 v[94:95], v[94:95], v[86:87]
v_cvt_pk_bf16_f32 v128, v40, v41
v_cvt_pk_bf16_f32 v129, v42, v43
v_cvt_pk_bf16_f32 v130, v44, v45
v_cvt_pk_bf16_f32 v131, v46, v47
v_cvt_pk_bf16_f32 v132, v88, v89
v_cvt_pk_bf16_f32 v133, v90, v91
v_cvt_pk_bf16_f32 v134, v92, v93
v_cvt_pk_bf16_f32 v135, v94, v95
s_add_u32 s52, s42, 0
buffer_store_dwordx4 v[128:131], v2, s[4:7], s52 offen sc1
s_add_u32 s52, s42, 49152
buffer_store_dwordx4 v[132:135], v2, s[4:7], s52 offen sc1
v_pk_mul_f32 v[48:49], v[48:49], v[208:209] op_sel_hi:[1,0]
v_pk_mul_f32 v[52:53], v[52:53], v[208:209] op_sel_hi:[1,0]
v_pk_mul_f32 v[96:97], v[96:97], v[210:211] op_sel_hi:[1,0]
v_pk_mul_f32 v[100:101], v[100:101], v[210:211] op_sel_hi:[1,0]
v_exp_f32 v48, v48
v_exp_f32 v52, v52
v_exp_f32 v96, v96
v_exp_f32 v100, v100
v_exp_f32 v49, v49
v_exp_f32 v53, v53
v_exp_f32 v97, v97
v_exp_f32 v101, v101
s_add_u32 m0, s64, 69632
s_add_u32 s37, s65, 131072
buffer_load_dwordx4 v2, s[4:7], s37 offen sc1 lds
v_pk_fma_f32 v[48:49], v[48:49], v[212:213], v[212:213] op_sel_hi:[1,0,0]
v_pk_fma_f32 v[52:53], v[52:53], v[212:213], v[212:213] op_sel_hi:[1,0,0]
v_pk_fma_f32 v[96:97], v[96:97], v[214:215], v[214:215] op_sel_hi:[1,0,0]
v_pk_fma_f32 v[100:101], v[100:101], v[214:215], v[214:215] op_sel_hi:[1,0,0]
v_rcp_f32 v48, v48
v_rcp_f32 v52, v52
v_rcp_f32 v96, v96
v_rcp_f32 v100, v100
v_rcp_f32 v49, v49
v_rcp_f32 v53, v53
v_rcp_f32 v97, v97
v_rcp_f32 v101, v101
s_add_u32 m0, s64, 73728
s_add_u32 s37, s65, 135168
buffer_load_dwordx4 v2, s[4:7], s37 offen sc1 lds
v_pk_mul_f32 v[56:57], v[56:57], v[48:49]
v_pk_mul_f32 v[60:61], v[60:61], v[52:53]
v_pk_mul_f32 v[104:105], v[104:105], v[96:97]
v_pk_mul_f32 v[108:109], v[108:109], v[100:101]
v_pk_mul_f32 v[50:51], v[50:51], v[208:209] op_sel_hi:[1,0]
v_pk_mul_f32 v[54:55], v[54:55], v[208:209] op_sel_hi:[1,0]
v_pk_mul_f32 v[98:99], v[98:99], v[210:211] op_sel_hi:[1,0]
v_pk_mul_f32 v[102:103], v[102:103], v[210:211] op_sel_hi:[1,0]
v_exp_f32 v50, v50
v_exp_f32 v54, v54
v_exp_f32 v98, v98
v_exp_f32 v102, v102
s_add_u32 m0, s64, 77824
s_add_u32 s37, s65, 139264
buffer_load_dwordx4 v2, s[4:7], s37 offen sc1 lds
v_exp_f32 v51, v51
v_exp_f32 v55, v55
v_exp_f32 v99, v99
v_exp_f32 v103, v103
v_pk_fma_f32 v[50:51], v[50:51], v[212:213], v[212:213] op_sel_hi:[1,0,0]
v_pk_fma_f32 v[54:55], v[54:55], v[212:213], v[212:213] op_sel_hi:[1,0,0]
v_pk_fma_f32 v[98:99], v[98:99], v[214:215], v[214:215] op_sel_hi:[1,0,0]
v_pk_fma_f32 v[102:103], v[102:103], v[214:215], v[214:215] op_sel_hi:[1,0,0]
v_rcp_f32 v50, v50
v_rcp_f32 v54, v54
v_rcp_f32 v98, v98
v_rcp_f32 v102, v102
s_add_u32 m0, s64, 81920
s_add_u32 s37, s65, 143360
buffer_load_dwordx4 v2, s[4:7], s37 offen sc1 lds
v_rcp_f32 v51, v51
v_rcp_f32 v55, v55
v_rcp_f32 v99, v99
v_rcp_f32 v103, v103
v_pk_mul_f32 v[58:59], v[58:59], v[50:51]
v_pk_mul_f32 v[62:63], v[62:63], v[54:55]
v_pk_mul_f32 v[106:107], v[106:107], v[98:99]
v_pk_mul_f32 v[110:111], v[110:111], v[102:103]
v_cvt_pk_bf16_f32 v136, v56, v57
v_cvt_pk_bf16_f32 v137, v58, v59
v_cvt_pk_bf16_f32 v138, v60, v61
v_cvt_pk_bf16_f32 v139, v62, v63
v_cvt_pk_bf16_f32 v140, v104, v105
v_cvt_pk_bf16_f32 v141, v106, v107
v_cvt_pk_bf16_f32 v142, v108, v109
v_cvt_pk_bf16_f32 v143, v110, v111
s_add_u32 s52, s42, 8192
buffer_store_dwordx4 v[136:139], v2, s[4:7], s52 offen sc1
s_add_u32 s52, s42, 57344
buffer_store_dwordx4 v[140:143], v2, s[4:7], s52 offen sc1
v_pk_mul_f32 v[64:65], v[64:65], v[208:209] op_sel_hi:[1,0]
v_pk_mul_f32 v[68:69], v[68:69], v[208:209] op_sel_hi:[1,0]
v_pk_mul_f32 v[112:113], v[112:113], v[210:211] op_sel_hi:[1,0]
v_pk_mul_f32 v[116:117], v[116:117], v[210:211] op_sel_hi:[1,0]
v_exp_f32 v64, v64
v_exp_f32 v68, v68
v_exp_f32 v112, v112
v_exp_f32 v116, v116
v_exp_f32 v65, v65
v_exp_f32 v69, v69
v_exp_f32 v113, v113
v_exp_f32 v117, v117
s_add_u32 m0, s64, 86016
s_add_u32 s37, s65, 147456
buffer_load_dwordx4 v2, s[4:7], s37 offen sc1 lds
v_pk_fma_f32 v[64:65], v[64:65], v[212:213], v[212:213] op_sel_hi:[1,0,0]
v_pk_fma_f32 v[68:69], v[68:69], v[212:213], v[212:213] op_sel_hi:[1,0,0]
v_pk_fma_f32 v[112:113], v[112:113], v[214:215], v[214:215] op_sel_hi:[1,0,0]
v_pk_fma_f32 v[116:117], v[116:117], v[214:215], v[214:215] op_sel_hi:[1,0,0]
v_rcp_f32 v64, v64
v_rcp_f32 v68, v68
v_rcp_f32 v112, v112
v_rcp_f32 v116, v116
v_rcp_f32 v65, v65
v_rcp_f32 v69, v69
v_rcp_f32 v113, v113
v_rcp_f32 v117, v117
s_add_u32 m0, s64, 90112
s_add_u32 s37, s65, 151552
buffer_load_dwordx4 v2, s[4:7], s37 offen sc1 lds
v_pk_mul_f32 v[72:73], v[72:73], v[64:65]
v_pk_mul_f32 v[76:77], v[76:77], v[68:69]
v_pk_mul_f32 v[120:121], v[120:121], v[112:113]
v_pk_mul_f32 v[124:125], v[124:125], v[116:117]
v_pk_mul_f32 v[66:67], v[66:67], v[208:209] op_sel_hi:[1,0]
v_pk_mul_f32 v[70:71], v[70:71], v[208:209] op_sel_hi:[1,0]
v_pk_mul_f32 v[114:115], v[114:115], v[210:211] op_sel_hi:[1,0]
v_pk_mul_f32 v[118:119], v[118:119], v[210:211] op_sel_hi:[1,0]
v_exp_f32 v66, v66
v_exp_f32 v70, v70
v_exp_f32 v114, v114
v_exp_f32 v118, v118
s_add_u32 m0, s64, 94208
s_add_u32 s37, s65, 155648
buffer_load_dwordx4 v2, s[4:7], s37 offen sc1 lds
v_exp_f32 v67, v67
v_exp_f32 v71, v71
v_exp_f32 v115, v115
v_exp_f32 v119, v119
v_pk_fma_f32 v[66:67], v[66:67], v[212:213], v[212:213] op_sel_hi:[1,0,0]
v_pk_fma_f32 v[70:71], v[70:71], v[212:213], v[212:213] op_sel_hi:[1,0,0]
v_pk_fma_f32 v[114:115], v[114:115], v[214:215], v[214:215] op_sel_hi:[1,0,0]
v_pk_fma_f32 v[118:119], v[118:119], v[214:215], v[214:215] op_sel_hi:[1,0,0]
v_rcp_f32 v66, v66
v_rcp_f32 v70, v70
v_rcp_f32 v114, v114
v_rcp_f32 v118, v118
s_add_u32 m0, s64, 98304
s_add_u32 s37, s65, 159744
buffer_load_dwordx4 v2, s[4:7], s37 offen sc1 lds
v_rcp_f32 v67, v67
v_rcp_f32 v71, v71
v_rcp_f32 v115, v115
v_rcp_f32 v119, v119
v_pk_mul_f32 v[74:75], v[74:75], v[66:67]
v_pk_mul_f32 v[78:79], v[78:79], v[70:71]
v_pk_mul_f32 v[122:123], v[122:123], v[114:115]
v_pk_mul_f32 v[126:127], v[126:127], v[118:119]
v_cvt_pk_bf16_f32 v128, v72, v73
v_cvt_pk_bf16_f32 v129, v74, v75
v_cvt_pk_bf16_f32 v130, v76, v77
v_cvt_pk_bf16_f32 v131, v78, v79
v_cvt_pk_bf16_f32 v132, v120, v121
v_cvt_pk_bf16_f32 v133, v122, v123
v_cvt_pk_bf16_f32 v134, v124, v125
v_cvt_pk_bf16_f32 v135, v126, v127
s_add_u32 s52, s42, 16384
buffer_store_dwordx4 v[128:131], v2, s[4:7], s52 offen sc1
s_add_u32 s52, s42, 65536
buffer_store_dwordx4 v[132:135], v2, s[4:7], s52 offen sc1
s_lshl_b32 s50, s17, 3
s_lshl_b32 s51, s61, 2
s_add_u32 s50, s50, s51
s_add_u32 s50, s50, s16
s_mul_i32 s20, s50, 49152
s_mul_i32 s51, s63, 24576
s_add_u32 s20, s20, s51
s_add_u32 s20, s20, 0xed0000
s_cmp_eq_u32 s63, 0
s_cselect_b32 s51, 0, 49152
s_cselect_b32 s52, 49152, 0
s_sub_u32 s20, s20, s51
v_add_u32 v7, s51, v2
v_add_u32 v6, s52, v2
s_mul_i32 s51, s63, 5120
v_add_u32 v3, s51, v2
v_add_u32 v4, 61440, v3
v_add_u32 v5, 122880, v3
s_mul_i32 s50, s16, 5120
s_add_u32 s50, s50, 102400
v_add_u32 v8, s50, v2
s_xor_b32 s51, s16, 1
s_mul_i32 s51, s51, 5120
s_add_u32 s51, s51, 102400
v_add_u32 v9, s51, v2
s_mov_b32 s12, s54
s_and_b32 s13, s55, 0xffff
s_mov_b32 s14, 0x280000
s_mov_b32 s15, 0x20000
s_lshl_b32 s50, s17, 7
s_add_u32 s50, s50, 0x5000
v_mov_b32 v228, s50
s_waitcnt vmcnt(12)
s_barrier
s_cmp_lg_u32 s16, 0
s_cbranch_scc1 L_arr_33
s_lshl_b32 s3, s17, 7
s_add_u32 s3, s3, 0x4000
v_mov_b32 v14, s3
v_mov_b32 v15, 1
s_mov_b64 exec, 1
buffer_atomic_add v15, v14, s[4:7], 0 offen sc1
s_mov_b64 exec, -1
L_arr_33:
s_waitcnt vmcnt(0)
s_barrier
s_cmp_lg_u32 s16, 0
s_cbranch_scc1 L_arr_34
s_lshl_b32 s3, s17, 7
s_add_u32 s3, s3, 0x5000
v_mov_b32 v14, s3
v_mov_b32 v15, 1
s_mov_b64 exec, 1
buffer_atomic_add v15, v14, s[4:7], 0 offen sc1
s_mov_b64 exec, -1
L_arr_34:
s_cmp_lg_u32 s16, 0
s_cbranch_scc1 L_wg_g3_35
s_lshl_b32 s3, s17, 7
s_add_u32 s3, s3, 0x4000
v_mov_b32 v14, s3
s_add_u32 s37, s19, 16
s_mov_b32 s3, 0
L_poll_g3_36:
buffer_load_dword v16, v14, s[4:7], 0 offen sc1
s_add_u32 s3, s3, 1
s_cmp_gt_u32 s3, 400000
s_cbranch_scc1 L_polld_g3_37
s_waitcnt vmcnt(0)
v_cmp_ne_u32 vcc, s37, v16
s_nop 3
s_cmp_eq_u64 vcc, 0
s_cbranch_scc0 L_poll_g3_36
L_polld_g3_37:
s_waitcnt vmcnt(0)
L_wg_g3_35:
s_barrier
s_add_u32 s38, s20, 0
buffer_load_dwordx4 a[0:3], v7, s[4:7], s38 offen offset:0 sc1
buffer_load_dwordx4 a[4:7], v6, s[4:7], s38 offen offset:0 sc1
buffer_load_dwordx4 a[8:11], v7, s[4:7], s38 offen offset:1024 sc1
buffer_load_dwordx4 a[12:15], v6, s[4:7], s38 offen offset:1024 sc1
buffer_load_dwordx4 a[16:19], v7, s[4:7], s38 offen offset:2048 sc1
buffer_load_dwordx4 a[20:23], v6, s[4:7], s38 offen offset:2048 sc1
buffer_load_dwordx4 a[24:27], v7, s[4:7], s38 offen offset:3072 sc1
buffer_load_dwordx4 a[28:31], v6, s[4:7], s38 offen offset:3072 sc1
s_add_u32 s38, s20, 4096
buffer_load_dwordx4 a[32:35], v7, s[4:7], s38 offen offset:0 sc1
buffer_load_dwordx4 a[36:39], v6, s[4:7], s38 offen offset:0 sc1
s_barrier
ds_read_b128 a[200:203], v4 offset:40960
ds_read_b128 a[204:207], v4 offset:41984
ds_read_b128 a[208:211], v4 offset:43008
ds_read_b128 a[212:215], v4 offset:44032
ds_read_b128 a[216:219], v4 offset:45056
s_waitcnt vmcnt(8) lgkmcnt(0)
v_mfma_f32_16x16x32_bf16 v[32:35], a[200:203], a[0:3], 0
ds_read_b128 a[220:223], v4 offset:51200
v_mfma_f32_16x16x32_bf16 v[52:55], a[200:203], a[4:7], 0
buffer_load_dwordx4 a[40:43], v7, s[4:7], s38 offen offset:1024 sc1
v_mfma_f32_16x16x32_bf16 v[36:39], a[204:207], a[0:3], 0
ds_read_b128 a[224:227], v4 offset:52224
v_mfma_f32_16x16x32_bf16 v[56:59], a[204:207], a[4:7], 0
buffer_load_dwordx4 a[44:47], v6, s[4:7], s38 offen offset:1024 sc1
v_mfma_f32_16x16x32_bf16 v[40:43], a[208:211], a[0:3], 0
ds_read_b128 a[228:231], v4 offset:53248
v_mfma_f32_16x16x32_bf16 v[60:63], a[208:211], a[4:7], 0
buffer_load_dwordx4 a[48:51], v7, s[4:7], s38 offen offset:2048 sc1
v_mfma_f32_16x16x32_bf16 v[44:47], a[212:215], a[0:3], 0
ds_read_b128 a[232:235], v4 offset:54272
v_mfma_f32_16x16x32_bf16 v[64:67], a[212:215], a[4:7], 0
buffer_load_dwordx4 a[52:55], v6, s[4:7], s38 offen offset:2048 sc1
v_mfma_f32_16x16x32_bf16 v[48:51], a[216:219], a[0:3], 0
ds_read_b128 a[236:239], v4 offset:55296
v_mfma_f32_16x16x32_bf16 v[68:71], a[216:219], a[4:7], 0
s_waitcnt vmcnt(10) lgkmcnt(0)
v_mfma_f32_16x16x32_bf16 v[32:35], a[220:223], a[8:11], v[32:35]
ds_read_b128 a[200:203], v3 offset:0
v_mfma_f32_16x16x32_bf16 v[52:55], a[220:223], a[12:15], v[52:55]
buffer_load_dword v229, v228, s[4:7], 0 offen sc1
v_mfma_f32_16x16x32_bf16 v[36:39], a[224:227], a[8:11], v[36:39]
ds_read_b128 a[204:207], v3 offset:1024
v_mfma_f32_16x16x32_bf16 v[56:59], a[224:227], a[12:15], v[56:59]
buffer_load_dwordx4 a[56:59], v7, s[4:7], s38 offen offset:3072 sc1
v_mfma_f32_16x16x32_bf16 v[40:43], a[228:231], a[8:11], v[40:43]
ds_read_b128 a[208:211], v3 offset:2048
v_mfma_f32_16x16x32_bf16 v[60:63], a[228:231], a[12:15], v[60:63]
buffer_load_dwordx4 a[60:63], v6, s[4:7], s38 offen offset:3072 sc1
v_mfma_f32_16x16x32_bf16 v[44:47], a[232:235], a[8:11], v[44:47]
ds_read_b128 a[212:215], v3 offset:3072
v_mfma_f32_16x16x32_bf16 v[64:67], a[232:235], a[12:15], v[64:67]
v_mfma_f32_16x16x32_bf16 v[48:51], a[236:239], a[8:11], v[48:51]
ds_read_b128 a[216:219], v3 offset:4096
v_mfma_f32_16x16x32_bf16 v[68:71], a[236:239], a[12:15], v[68:71]
s_waitcnt vmcnt(11)
s_barrier
s_waitcnt lgkmcnt(0)
v_mfma_f32_16x16x32_bf16 v[32:35], a[200:203], a[16:19], v[32:35]
ds_read_b128 a[220:223], v3 offset:10240
v_mfma_f32_16x16x32_bf16 v[52:55], a[200:203], a[20:23], v[52:55]
s_add_u32 m0, s64, 102400
s_add_u32 s37, s65, 163840
buffer_load_dwordx4 v2, s[4:7], s37 offen sc1 lds
v_mfma_f32_16x16x32_bf16 v[36:39], a[204:207], a[16:19], v[36:39]
ds_read_b128 a[224:227], v3 offset:11264
v_mfma_f32_16x16x32_bf16 v[56:59], a[204:207], a[20:23], v[56:59]
v_mfma_f32_16x16x32_bf16 v[40:43], a[208:211], a[16:19], v[40:43]
ds_read_b128 a[228:231], v3 offset:12288
v_mfma_f32_16x16x32_bf16 v[60:63], a[208:211], a[20:23], v[60:63]
v_mfma_f32_16x16x32_bf16 v[44:47], a[212:215], a[16:19], v[44:47]
ds_read_b128 a[232:235], v3 offset:13312
v_mfma_f32_16x16x32_bf16 v[64:67], a[212:215], a[20:23], v[64:67]
v_mfma_f32_16x16x32_bf16 v[48:51], a[216:219], a[16:19], v[48:51]
ds_read_b128 a[236:239], v3 offset:14336
v_mfma_f32_16x16x32_bf16 v[68:71], a[216:219], a[20:23], v[68:71]
s_waitcnt vmcnt(3)
s_add_u32 s3, s19, 16
v_cmp_ne_u32 vcc, s3, v229
s_nop 3
s_cmp_eq_u64 vcc, 0
s_cbranch_scc1 L_ok_g3b_38
s_mov_b32 s69, s3
s_mov_b32 s3, 0
L_poll_g3b_39:
buffer_load_dword v229, v228, s[4:7], 0 offen sc1
s_add_u32 s3, s3, 1
s_cmp_gt_u32 s3, 400000
s_cbranch_scc1 L_polld_g3b_40
s_waitcnt vmcnt(0)
v_cmp_ne_u32 vcc, s69, v229
s_nop 3
s_cmp_eq_u64 vcc, 0
s_cbranch_scc0 L_poll_g3b_39
L_polld_g3b_40:
s_waitcnt vmcnt(0)
L_ok_g3b_38:
s_waitcnt lgkmcnt(0)
v_mfma_f32_16x16x32_bf16 v[32:35], a[220:223], a[24:27], v[32:35]
ds_read_b128 a[200:203], v3 offset:20480
v_mfma_f32_16x16x32_bf16 v[52:55], a[220:223], a[28:31], v[52:55]
s_add_u32 s38, s20, 8192
buffer_load_dwordx4 a[64:67], v7, s[4:7], s38 offen offset:0 sc1
v_mfma_f32_16x16x32_bf16 v[36:39], a[224:227], a[24:27], v[36:39]
ds_read_b128 a[204:207], v3 offset:21504
v_mfma_f32_16x16x32_bf16 v[56:59], a[224:227], a[28:31], v[56:59]
buffer_load_dwordx4 a[68:71], v6, s[4:7], s38 offen offset:0 sc1
v_mfma_f32_16x16x32_bf16 v[40:43], a[228:231], a[24:27], v[40:43]
ds_read_b128 a[208:211], v3 offset:22528
v_mfma_f32_16x16x32_bf16 v[60:63], a[228:231], a[28:31], v[60:63]
s_add_u32 m0, s64, 106496
s_add_u32 s37, s65, 167936
buffer_load_dwordx4 v2, s[4:7], s37 offen sc1 lds
v_mfma_f32_16x16x32_bf16 v[44:47], a[232:235], a[24:27], v[44:47]
ds_read_b128 a[212:215], v3 offset:23552
v_mfma_f32_16x16x32_bf16 v[64:67], a[232:235], a[28:31], v[64:67]
v_mfma_f32_16x16x32_bf16 v[48:51], a[236:239], a[24:27], v[48:51]
ds_read_b128 a[216:219], v3 offset:24576
v_mfma_f32_16x16x32_bf16 v[68:71], a[236:239], a[28:31], v[68:71]
s_waitcnt lgkmcnt(0)
v_mfma_f32_16x16x32_bf16 v[32:35], a[200:203], a[32:35], v[32:35]
ds_read_b128 a[220:223], v3 offset:30720
v_mfma_f32_16x16x32_bf16 v[52:55], a[200:203], a[36:39], v[52:55]
buffer_load_dwordx4 a[72:75], v7, s[4:7], s38 offen offset:1024 sc1
v_mfma_f32_16x16x32_bf16 v[36:39], a[204:207], a[32:35], v[36:39]
ds_read_b128 a[224:227], v3 offset:31744
v_mfma_f32_16x16x32_bf16 v[56:59], a[204:207], a[36:39], v[56:59]
buffer_load_dwordx4 a[76:79], v6, s[4:7], s38 offen offset:1024 sc1
v_mfma_f32_16x16x32_bf16 v[40:43], a[208:211], a[32:35], v[40:43]
ds_read_b128 a[228:231], v3 offset:32768
v_mfma_f32_16x16x32_bf16 v[60:63], a[208:211], a[36:39], v[60:63]
s_add_u32 m0, s64, 110592
s_add_u32 s37, s65, 172032
buffer_load_dwordx4 v2, s[4:7], s37 offen sc1 lds
v_mfma_f32_16x16x32_bf16 v[44:47], a[212:215], a[32:35], v[44:47]
ds_read_b128 a[232:235], v3 offset:33792
v_mfma_f32_16x16x32_bf16 v[64:67], a[212:215], a[36:39], v[64:67]
v_mfma_f32_16x16x32_bf16 v[48:51], a[216:219], a[32:35], v[48:51]
ds_read_b128 a[236:239], v3 offset:34816
v_mfma_f32_16x16x32_bf16 v[68:71], a[216:219], a[36:39], v[68:71]
s_waitcnt lgkmcnt(0)
v_mfma_f32_16x16x32_bf16 v[32:35], a[220:223], a[40:43], v[32:35]
ds_read_b128 a[200:203], v5 offset:0
v_mfma_f32_16x16x32_bf16 v[52:55], a[220:223], a[44:47], v[52:55]
buffer_load_dwordx4 a[80:83], v7, s[4:7], s38 offen offset:2048 sc1
v_mfma_f32_16x16x32_bf16 v[36:39], a[224:227], a[40:43], v[36:39]
ds_read_b128 a[204:207], v5 offset:1024
v_mfma_f32_16x16x32_bf16 v[56:59], a[224:227], a[44:47], v[56:59]
buffer_load_dwordx4 a[84:87], v6, s[4:7], s38 offen offset:2048 sc1
v_mfma_f32_16x16x32_bf16 v[40:43], a[228:231], a[40:43], v[40:43]
ds_read_b128 a[208:211], v5 offset:2048
v_mfma_f32_16x16x32_bf16 v[60:63], a[228:231], a[44:47], v[60:63]
s_add_u32 m0, s64, 114688
s_add_u32 s37, s65, 176128
buffer_load_dwordx4 v2, s[4:7], s37 offen sc1 lds
v_mfma_f32_16x16x32_bf16 v[44:47], a[232:235], a[40:43], v[44:47]
ds_read_b128 a[212:215], v5 offset:3072
v_mfma_f32_16x16x32_bf16 v[64:67], a[232:235], a[44:47], v[64:67]
s_add_u32 m0, s64, 118784
s_add_u32 s37, s65, 180224
buffer_load_dwordx4 v2, s[4:7], s37 offen sc1 lds
v_mfma_f32_16x16x32_bf16 v[48:51], a[236:239], a[40:43], v[48:51]
ds_read_b128 a[216:219], v5 offset:4096
v_mfma_f32_16x16x32_bf16 v[68:71], a[236:239], a[44:47], v[68:71]
s_barrier
s_waitcnt lgkmcnt(0)
v_mfma_f32_16x16x32_bf16 v[32:35], a[200:203], a[48:51], v[32:35]
ds_read_b128 a[220:223], v5 offset:10240
v_mfma_f32_16x16x32_bf16 v[52:55], a[200:203], a[52:55], v[52:55]
buffer_load_dwordx4 a[88:91], v7, s[4:7], s38 offen offset:3072 sc1
v_mfma_f32_16x16x32_bf16 v[36:39], a[204:207], a[48:51], v[36:39]
ds_read_b128 a[224:227], v5 offset:11264
v_mfma_f32_16x16x32_bf16 v[56:59], a[204:207], a[52:55], v[56:59]
buffer_load_dwordx4 a[92:95], v6, s[4:7], s38 offen offset:3072 sc1
v_mfma_f32_16x16x32_bf16 v[40:43], a[208:211], a[48:51], v[40:43]
ds_read_b128 a[228:231], v5 offset:12288
v_mfma_f32_16x16x32_bf16 v[60:63], a[208:211], a[52:55], v[60:63]
s_add_u32 m0, s64, 0
s_add_u32 s37, s65, 184320
buffer_load_dwordx4 v2, s[4:7], s37 offen sc1 lds
v_mfma_f32_16x16x32_bf16 v[44:47], a[212:215], a[48:51], v[44:47]
ds_read_b128 a[232:235], v5 offset:13312
v_mfma_f32_16x16x32_bf16 v[64:67], a[212:215], a[52:55], v[64:67]
v_mfma_f32_16x16x32_bf16 v[48:51], a[216:219], a[48:51], v[48:51]
ds_read_b128 a[236:239], v5 offset:14336
v_mfma_f32_16x16x32_bf16 v[68:71], a[216:219], a[52:55], v[68:71]
s_waitcnt lgkmcnt(0)
v_mfma_f32_16x16x32_bf16 v[32:35], a[220:223], a[56:59], v[32:35]
ds_read_b128 a[200:203], v5 offset:20480
v_mfma_f32_16x16x32_bf16 v[52:55], a[220:223], a[60:63], v[52:55]
s_add_u32 s38, s20, 12288
buffer_load_dwordx4 a[96:99], v7, s[4:7], s38 offen offset:0 sc1
v_mfma_f32_16x16x32_bf16 v[36:39], a[224:227], a[56:59], v[36:39]
ds_read_b128 a[204:207], v5 offset:21504
v_mfma_f32_16x16x32_bf16 v[56:59], a[224:227], a[60:63], v[56:59]
buffer_load_dwordx4 a[100:103], v6, s[4:7], s38 offen offset:0 sc1
v_mfma_f32_16x16x32_bf16 v[40:43], a[228:231], a[56:59], v[40:43]
ds_read_b128 a[208:211], v5 offset:22528
v_mfma_f32_16x16x32_bf16 v[60:63], a[228:231], a[60:63], v[60:63]
s_add_u32 m0, s64, 4096
s_add_u32 s37, s65, 188416
buffer_load_dwordx4 v2, s[4:7], s37 offen sc1 lds
v_mfma_f32_16x16x32_bf16 v[44:47], a[232:235], a[56:59], v[44:47]
ds_read_b128 a[212:215], v5 offset:23552
v_mfma_f32_16x16x32_bf16 v[64:67], a[232:235], a[60:63], v[64:67]
v_mfma_f32_16x16x32_bf16 v[48:51], a[236:239], a[56:59], v[48:51]
ds_read_b128 a[216:219], v5 offset:24576
v_mfma_f32_16x16x32_bf16 v[68:71], a[236:239], a[60:63], v[68:71]
s_waitcnt vmcnt(14) lgkmcnt(0)
v_mfma_f32_16x16x32_bf16 v[32:35], a[200:203], a[64:67], v[32:35]
ds_read_b128 a[220:223], v5 offset:30720
v_mfma_f32_16x16x32_bf16 v[52:55], a[200:203], a[68:71], v[52:55]
buffer_load_dwordx4 a[104:107], v7, s[4:7], s38 offen offset:1024 sc1
v_mfma_f32_16x16x32_bf16 v[36:39], a[204:207], a[64:67], v[36:39]
ds_read_b128 a[224:227], v5 offset:31744
v_mfma_f32_16x16x32_bf16 v[56:59], a[204:207], a[68:71], v[56:59]
buffer_load_dwordx4 a[108:111], v6, s[4:7], s38 offen offset:1024 sc1
v_mfma_f32_16x16x32_bf16 v[40:43], a[208:211], a[64:67], v[40:43]
ds_read_b128 a[228:231], v5 offset:32768
v_mfma_f32_16x16x32_bf16 v[60:63], a[208:211], a[68:71], v[60:63]
s_add_u32 m0, s64, 8192
s_add_u32 s37, s65, 192512
buffer_load_dwordx4 v2, s[4:7], s37 offen sc1 lds
v_mfma_f32_16x16x32_bf16 v[44:47], a[212:215], a[64:67], v[44:47]
ds_read_b128 a[232:235], v5 offset:33792
v_mfma_f32_16x16x32_bf16 v[64:67], a[212:215], a[68:71], v[64:67]
v_mfma_f32_16x16x32_bf16 v[48:51], a[216:219], a[64:67], v[48:51]
ds_read_b128 a[236:239], v5 offset:34816
v_mfma_f32_16x16x32_bf16 v[68:71], a[216:219], a[68:71], v[68:71]
s_waitcnt vmcnt(14) lgkmcnt(0)
v_mfma_f32_16x16x32_bf16 v[32:35], a[220:223], a[72:75], v[32:35]
ds_read_b128 a[200:203], v3 offset:40960
v_mfma_f32_16x16x32_bf16 v[52:55], a[220:223], a[76:79], v[52:55]
buffer_load_dwordx4 a[112:115], v7, s[4:7], s38 offen offset:2048 sc1
v_mfma_f32_16x16x32_bf16 v[36:39], a[224:227], a[72:75], v[36:39]
ds_read_b128 a[204:207], v3 offset:41984
v_mfma_f32_16x16x32_bf16 v[56:59], a[224:227], a[76:79], v[56:59]
buffer_load_dwordx4 a[116:119], v6, s[4:7], s38 offen offset:2048 sc1
v_mfma_f32_16x16x32_bf16 v[40:43], a[228:231], a[72:75], v[40:43]
ds_read_b128 a[208:211], v3 offset:43008
v_mfma_f32_16x16x32_bf16 v[60:63], a[228:231], a[76:79], v[60:63]
s_add_u32 m0, s64, 12288
s_add_u32 s37, s65, 196608
buffer_load_dwordx4 v2, s[4:7], s37 offen sc1 lds
v_mfma_f32_16x16x32_bf16 v[44:47], a[232:235], a[72:75], v[44:47]
ds_read_b128 a[212:215], v3 offset:44032
v_mfma_f32_16x16x32_bf16 v[64:67], a[232:235], a[76:79], v[64:67]
s_add_u32 m0, s64, 16384
s_add_u32 s37, s65, 200704
buffer_load_dwordx4 v2, s[4:7], s37 offen sc1 lds
v_mfma_f32_16x16x32_bf16 v[48:51], a[236:239], a[72:75], v[48:51]
ds_read_b128 a[216:219], v3 offset:45056
v_mfma_f32_16x16x32_bf16 v[68:71], a[236:239], a[76:79], v[68:71]
s_waitcnt vmcnt(15)
s_barrier
s_waitcnt lgkmcnt(0)
v_mfma_f32_16x16x32_bf16 v[32:35], a[200:203], a[80:83], v[32:35]
ds_read_b128 a[220:223], v3 offset:51200
v_mfma_f32_16x16x32_bf16 v[52:55], a[200:203], a[84:87], v[52:55]
buffer_load_dwordx4 a[120:123], v7, s[4:7], s38 offen offset:3072 sc1
v_mfma_f32_16x16x32_bf16 v[36:39], a[204:207], a[80:83], v[36:39]
ds_read_b128 a[224:227], v3 offset:52224
v_mfma_f32_16x16x32_bf16 v[56:59], a[204:207], a[84:87], v[56:59]
buffer_load_dwordx4 a[124:127], v6, s[4:7], s38 offen offset:3072 sc1
v_mfma_f32_16x16x32_bf16 v[40:43], a[208:211], a[80:83], v[40:43]
ds_read_b128 a[228:231], v3 offset:53248
v_mfma_f32_16x16x32_bf16 v[60:63], a[208:211], a[84:87], v[60:63]
s_add_u32 m0, s64, 20480
s_add_u32 s37, s65, 204800
buffer_load_dwordx4 v2, s[4:7], s37 offen sc1 lds
v_mfma_f32_16x16x32_bf16 v[44:47], a[212:215], a[80:83], v[44:47]
ds_read_b128 a[232:235], v3 offset:54272
v_mfma_f32_16x16x32_bf16 v[64:67], a[212:215], a[84:87], v[64:67]
v_mfma_f32_16x16x32_bf16 v[48:51], a[216:219], a[80:83], v[48:51]
ds_read_b128 a[236:239], v3 offset:55296
v_mfma_f32_16x16x32_bf16 v[68:71], a[216:219], a[84:87], v[68:71]
s_waitcnt vmcnt(14) lgkmcnt(0)
v_mfma_f32_16x16x32_bf16 v[32:35], a[220:223], a[88:91], v[32:35]
ds_read_b128 a[200:203], v4 offset:0
v_mfma_f32_16x16x32_bf16 v[52:55], a[220:223], a[92:95], v[52:55]
s_add_u32 s38, s20, 16384
buffer_load_dwordx4 a[128:131], v7, s[4:7], s38 offen offset:0 sc1
v_mfma_f32_16x16x32_bf16 v[36:39], a[224:227], a[88:91], v[36:39]
ds_read_b128 a[204:207], v4 offset:1024
v_mfma_f32_16x16x32_bf16 v[56:59], a[224:227], a[92:95], v[56:59]
buffer_load_dwordx4 a[132:135], v6, s[4:7], s38 offen offset:0 sc1
v_mfma_f32_16x16x32_bf16 v[40:43], a[228:231], a[88:91], v[40:43]
ds_read_b128 a[208:211], v4 offset:2048
v_mfma_f32_16x16x32_bf16 v[60:63], a[228:231], a[92:95], v[60:63]
s_add_u32 m0, s64, 24576
s_add_u32 s37, s65, 208896
buffer_load_dwordx4 v2, s[4:7], s37 offen sc1 lds
v_mfma_f32_16x16x32_bf16 v[44:47], a[232:235], a[88:91], v[44:47]
ds_read_b128 a[212:215], v4 offset:3072
v_mfma_f32_16x16x32_bf16 v[64:67], a[232:235], a[92:95], v[64:67]
v_mfma_f32_16x16x32_bf16 v[48:51], a[236:239], a[88:91], v[48:51]
ds_read_b128 a[216:219], v4 offset:4096
v_mfma_f32_16x16x32_bf16 v[68:71], a[236:239], a[92:95], v[68:71]
s_waitcnt vmcnt(14) lgkmcnt(0)
v_mfma_f32_16x16x32_bf16 v[32:35], a[200:203], a[96:99], v[32:35]
ds_read_b128 a[220:223], v4 offset:10240
v_mfma_f32_16x16x32_bf16 v[52:55], a[200:203], a[100:103], v[52:55]
buffer_load_dwordx4 a[136:139], v7, s[4:7], s38 offen offset:1024 sc1
v_mfma_f32_16x16x32_bf16 v[36:39], a[204:207], a[96:99], v[36:39]
ds_read_b128 a[224:227], v4 offset:11264
v_mfma_f32_16x16x32_bf16 v[56:59], a[204:207], a[100:103], v[56:59]
buffer_load_dwordx4 a[140:143], v6, s[4:7], s38 offen offset:1024 sc1
v_mfma_f32_16x16x32_bf16 v[40:43], a[208:211], a[96:99], v[40:43]
ds_read_b128 a[228:231], v4 offset:12288
v_mfma_f32_16x16x32_bf16 v[60:63], a[208:211], a[100:103], v[60:63]
s_add_u32 m0, s64, 28672
s_add_u32 s37, s65, 212992
buffer_load_dwordx4 v2, s[4:7], s37 offen sc1 lds
v_mfma_f32_16x16x32_bf16 v[44:47], a[212:215], a[96:99], v[44:47]
ds_read_b128 a[232:235], v4 offset:13312
v_mfma_f32_16x16x32_bf16 v[64:67], a[212:215], a[100:103], v[64:67]
v_mfma_f32_16x16x32_bf16 v[48:51], a[216:219], a[96:99], v[48:51]
ds_read_b128 a[236:239], v4 offset:14336
v_mfma_f32_16x16x32_bf16 v[68:71], a[216:219], a[100:103], v[68:71]
s_waitcnt vmcnt(14) lgkmcnt(0)
v_mfma_f32_16x16x32_bf16 v[32:35], a[220:223], a[104:107], v[32:35]
ds_read_b128 a[200:203], v4 offset:20480
v_mfma_f32_16x16x32_bf16 v[52:55], a[220:223], a[108:111], v[52:55]
buffer_load_dwordx4 a[144:147], v7, s[4:7], s38 offen offset:2048 sc1
v_mfma_f32_16x16x32_bf16 v[36:39], a[224:227], a[104:107], v[36:39]
ds_read_b128 a[204:207], v4 offset:21504
v_mfma_f32_16x16x32_bf16 v[56:59], a[224:227], a[108:111], v[56:59]
buffer_load_dwordx4 a[148:151], v6, s[4:7], s38 offen offset:2048 sc1
v_mfma_f32_16x16x32_bf16 v[40:43], a[228:231], a[104:107], v[40:43]
ds_read_b128 a[208:211], v4 offset:22528
v_mfma_f32_16x16x32_bf16 v[60:63], a[228:231], a[108:111], v[60:63]
s_add_u32 m0, s64, 32768
s_add_u32 s37, s65, 217088
buffer_load_dwordx4 v2, s[4:7], s37 offen sc1 lds
v_mfma_f32_16x16x32_bf16 v[44:47], a[232:235], a[104:107], v[44:47]
ds_read_b128 a[212:215], v4 offset:23552
v_mfma_f32_16x16x32_bf16 v[64:67], a[232:235], a[108:111], v[64:67]
s_add_u32 m0, s64, 36864
s_add_u32 s37, s65, 221184
buffer_load_dwordx4 v2, s[4:7], s37 offen sc1 lds
v_mfma_f32_16x16x32_bf16 v[48:51], a[236:239], a[104:107], v[48:51]
ds_read_b128 a[216:219], v4 offset:24576
v_mfma_f32_16x16x32_bf16 v[68:71], a[236:239], a[108:111], v[68:71]
s_waitcnt vmcnt(15)
s_barrier
s_waitcnt lgkmcnt(0)
v_mfma_f32_16x16x32_bf16 v[32:35], a[200:203], a[112:115], v[32:35]
ds_read_b128 a[220:223], v4 offset:30720
v_mfma_f32_16x16x32_bf16 v[52:55], a[200:203], a[116:119], v[52:55]
buffer_load_dwordx4 a[152:155], v7, s[4:7], s38 offen offset:3072 sc1
v_mfma_f32_16x16x32_bf16 v[36:39], a[204:207], a[112:115], v[36:39]
ds_read_b128 a[224:227], v4 offset:31744
v_mfma_f32_16x16x32_bf16 v[56:59], a[204:207], a[116:119], v[56:59]
buffer_load_dwordx4 a[156:159], v6, s[4:7], s38 offen offset:3072 sc1
v_mfma_f32_16x16x32_bf16 v[40:43], a[208:211], a[112:115], v[40:43]
ds_read_b128 a[228:231], v4 offset:32768
v_mfma_f32_16x16x32_bf16 v[60:63], a[208:211], a[116:119], v[60:63]
s_add_u32 m0, s64, 122880
s_add_u32 s37, s65, 225280
buffer_load_dwordx4 v2, s[4:7], s37 offen sc1 lds
v_mfma_f32_16x16x32_bf16 v[44:47], a[212:215], a[112:115], v[44:47]
ds_read_b128 a[232:235], v4 offset:33792
v_mfma_f32_16x16x32_bf16 v[64:67], a[212:215], a[116:119], v[64:67]
v_mfma_f32_16x16x32_bf16 v[48:51], a[216:219], a[112:115], v[48:51]
ds_read_b128 a[236:239], v4 offset:34816
v_mfma_f32_16x16x32_bf16 v[68:71], a[216:219], a[116:119], v[68:71]
s_waitcnt vmcnt(14)
s_barrier
s_waitcnt lgkmcnt(0)
v_mfma_f32_16x16x32_bf16 v[32:35], a[220:223], a[120:123], v[32:35]
ds_read_b128 a[200:203], v4 offset:40960
v_mfma_f32_16x16x32_bf16 v[52:55], a[220:223], a[124:127], v[52:55]
s_add_u32 s38, s20, 20480
buffer_load_dwordx4 a[160:163], v7, s[4:7], s38 offen offset:0 sc1
v_mfma_f32_16x16x32_bf16 v[36:39], a[224:227], a[120:123], v[36:39]
ds_read_b128 a[204:207], v4 offset:41984
v_mfma_f32_16x16x32_bf16 v[56:59], a[224:227], a[124:127], v[56:59]
buffer_load_dwordx4 a[164:167], v6, s[4:7], s38 offen offset:0 sc1
v_mfma_f32_16x16x32_bf16 v[40:43], a[228:231], a[120:123], v[40:43]
ds_read_b128 a[208:211], v4 offset:43008
v_mfma_f32_16x16x32_bf16 v[60:63], a[228:231], a[124:127], v[60:63]
s_add_u32 m0, s64, 126976
s_add_u32 s37, s65, 229376
buffer_load_dwordx4 v2, s[4:7], s37 offen sc1 lds
v_mfma_f32_16x16x32_bf16 v[44:47], a[232:235], a[120:123], v[44:47]
ds_read_b128 a[212:215], v4 offset:44032
v_mfma_f32_16x16x32_bf16 v[64:67], a[232:235], a[124:127], v[64:67]
v_mfma_f32_16x16x32_bf16 v[48:51], a[236:239], a[120:123], v[48:51]
ds_read_b128 a[216:219], v4 offset:45056
v_mfma_f32_16x16x32_bf16 v[68:71], a[236:239], a[124:127], v[68:71]
s_waitcnt vmcnt(14)
s_barrier
s_waitcnt lgkmcnt(0)
v_mfma_f32_16x16x32_bf16 v[32:35], a[200:203], a[128:131], v[32:35]
ds_read_b128 a[220:223], v4 offset:51200
v_mfma_f32_16x16x32_bf16 v[52:55], a[200:203], a[132:135], v[52:55]
buffer_load_dwordx4 a[168:171], v7, s[4:7], s38 offen offset:1024 sc1
v_mfma_f32_16x16x32_bf16 v[36:39], a[204:207], a[128:131], v[36:39]
ds_read_b128 a[224:227], v4 offset:52224
v_mfma_f32_16x16x32_bf16 v[56:59], a[204:207], a[132:135], v[56:59]
buffer_load_dwordx4 a[172:175], v6, s[4:7], s38 offen offset:1024 sc1
v_mfma_f32_16x16x32_bf16 v[40:43], a[208:211], a[128:131], v[40:43]
ds_read_b128 a[228:231], v4 offset:53248
v_mfma_f32_16x16x32_bf16 v[60:63], a[208:211], a[132:135], v[60:63]
s_add_u32 m0, s64, 131072
s_add_u32 s37, s65, 233472
buffer_load_dwordx4 v2, s[4:7], s37 offen sc1 lds
v_mfma_f32_16x16x32_bf16 v[44:47], a[212:215], a[128:131], v[44:47]
ds_read_b128 a[232:235], v4 offset:54272
v_mfma_f32_16x16x32_bf16 v[64:67], a[212:215], a[132:135], v[64:67]
v_mfma_f32_16x16x32_bf16 v[48:51], a[216:219], a[128:131], v[48:51]
ds_read_b128 a[236:239], v4 offset:55296
v_mfma_f32_16x16x32_bf16 v[68:71], a[216:219], a[132:135], v[68:71]
s_waitcnt vmcnt(14)
s_barrier
s_waitcnt lgkmcnt(0)
v_mfma_f32_16x16x32_bf16 v[32:35], a[220:223], a[136:139], v[32:35]
ds_read_b128 a[200:203], v3 offset:0
v_mfma_f32_16x16x32_bf16 v[52:55], a[220:223], a[140:143], v[52:55]
buffer_load_dwordx4 a[176:179], v7, s[4:7], s38 offen offset:2048 sc1
v_mfma_f32_16x16x32_bf16 v[36:39], a[224:227], a[136:139], v[36:39]
ds_read_b128 a[204:207], v3 offset:1024
v_mfma_f32_16x16x32_bf16 v[56:59], a[224:227], a[140:143], v[56:59]
buffer_load_dwordx4 a[180:183], v6, s[4:7], s38 offen offset:2048 sc1
v_mfma_f32_16x16x32_bf16 v[40:43], a[228:231], a[136:139], v[40:43]
ds_read_b128 a[208:211], v3 offset:2048
v_mfma_f32_16x16x32_bf16 v[60:63], a[228:231], a[140:143], v[60:63]
s_add_u32 m0, s64, 135168
s_add_u32 s37, s65, 237568
buffer_load_dwordx4 v2, s[4:7], s37 offen sc1 lds
v_mfma_f32_16x16x32_bf16 v[44:47], a[232:235], a[136:139], v[44:47]
ds_read_b128 a[212:215], v3 offset:3072
v_mfma_f32_16x16x32_bf16 v[64:67], a[232:235], a[140:143], v[64:67]
s_add_u32 m0, s64, 139264
s_add_u32 s37, s65, 241664
buffer_load_dwordx4 v2, s[4:7], s37 offen sc1 lds
v_mfma_f32_16x16x32_bf16 v[48:51], a[236:239], a[136:139], v[48:51]
ds_read_b128 a[216:219], v3 offset:4096
v_mfma_f32_16x16x32_bf16 v[68:71], a[236:239], a[140:143], v[68:71]
s_waitcnt vmcnt(15)
s_barrier
s_waitcnt lgkmcnt(0)
v_mfma_f32_16x16x32_bf16 v[32:35], a[200:203], a[144:147], v[32:35]
ds_read_b128 a[220:223], v3 offset:10240
v_mfma_f32_16x16x32_bf16 v[52:55], a[200:203], a[148:151], v[52:55]
buffer_load_dwordx4 a[184:187], v7, s[4:7], s38 offen offset:3072 sc1
v_mfma_f32_16x16x32_bf16 v[36:39], a[204:207], a[144:147], v[36:39]
ds_read_b128 a[224:227], v3 offset:11264
v_mfma_f32_16x16x32_bf16 v[56:59], a[204:207], a[148:151], v[56:59]
buffer_load_dwordx4 a[188:191], v6, s[4:7], s38 offen offset:3072 sc1
v_mfma_f32_16x16x32_bf16 v[40:43], a[208:211], a[144:147], v[40:43]
ds_read_b128 a[228:231], v3 offset:12288
v_mfma_f32_16x16x32_bf16 v[60:63], a[208:211], a[148:151], v[60:63]
v_mfma_f32_16x16x32_bf16 v[44:47], a[212:215], a[144:147], v[44:47]
ds_read_b128 a[232:235], v3 offset:13312
v_mfma_f32_16x16x32_bf16 v[64:67], a[212:215], a[148:151], v[64:67]
v_mfma_f32_16x16x32_bf16 v[48:51], a[216:219], a[144:147], v[48:51]
ds_read_b128 a[236:239], v3 offset:14336
v_mfma_f32_16x16x32_bf16 v[68:71], a[216:219], a[148:151], v[68:71]
s_waitcnt vmcnt(13)
s_barrier
s_waitcnt lgkmcnt(0)
v_mfma_f32_16x16x32_bf16 v[32:35], a[220:223], a[152:155], v[32:35]
ds_read_b128 a[200:203], v3 offset:20480
v_mfma_f32_16x16x32_bf16 v[52:55], a[220:223], a[156:159], v[52:55]
v_mfma_f32_16x16x32_bf16 v[36:39], a[224:227], a[152:155], v[36:39]
ds_read_b128 a[204:207], v3 offset:21504
v_mfma_f32_16x16x32_bf16 v[56:59], a[224:227], a[156:159], v[56:59]
v_mfma_f32_16x16x32_bf16 v[40:43], a[228:231], a[152:155], v[40:43]
ds_read_b128 a[208:211], v3 offset:22528
v_mfma_f32_16x16x32_bf16 v[60:63], a[228:231], a[156:159], v[60:63]
v_mfma_f32_16x16x32_bf16 v[44:47], a[232:235], a[152:155], v[44:47]
ds_read_b128 a[212:215], v3 offset:23552
v_mfma_f32_16x16x32_bf16 v[64:67], a[232:235], a[156:159], v[64:67]
v_mfma_f32_16x16x32_bf16 v[48:51], a[236:239], a[152:155], v[48:51]
ds_read_b128 a[216:219], v3 offset:24576
v_mfma_f32_16x16x32_bf16 v[68:71], a[236:239], a[156:159], v[68:71]
s_waitcnt vmcnt(10)
s_barrier
s_waitcnt lgkmcnt(0)
v_mfma_f32_16x16x32_bf16 v[32:35], a[200:203], a[160:163], v[32:35]
ds_read_b128 a[220:223], v3 offset:30720
v_mfma_f32_16x16x32_bf16 v[52:55], a[200:203], a[164:167], v[52:55]
v_mfma_f32_16x16x32_bf16 v[36:39], a[204:207], a[160:163], v[36:39]
ds_read_b128 a[224:227], v3 offset:31744
v_mfma_f32_16x16x32_bf16 v[56:59], a[204:207], a[164:167], v[56:59]
v_mfma_f32_16x16x32_bf16 v[40:43], a[208:211], a[160:163], v[40:43]
ds_read_b128 a[228:231], v3 offset:32768
v_mfma_f32_16x16x32_bf16 v[60:63], a[208:211], a[164:167], v[60:63]
v_mfma_f32_16x16x32_bf16 v[44:47], a[212:215], a[160:163], v[44:47]
ds_read_b128 a[232:235], v3 offset:33792
v_mfma_f32_16x16x32_bf16 v[64:67], a[212:215], a[164:167], v[64:67]
v_mfma_f32_16x16x32_bf16 v[48:51], a[216:219], a[160:163], v[48:51]
ds_read_b128 a[236:239], v3 offset:34816
v_mfma_f32_16x16x32_bf16 v[68:71], a[216:219], a[164:167], v[68:71]
s_waitcnt vmcnt(6)
s_barrier
s_waitcnt lgkmcnt(0)
v_mfma_f32_16x16x32_bf16 v[32:35], a[220:223], a[168:171], v[32:35]
ds_read_b128 a[200:203], v5 offset:0
v_mfma_f32_16x16x32_bf16 v[52:55], a[220:223], a[172:175], v[52:55]
v_mfma_f32_16x16x32_bf16 v[36:39], a[224:227], a[168:171], v[36:39]
ds_read_b128 a[204:207], v5 offset:1024
v_mfma_f32_16x16x32_bf16 v[56:59], a[224:227], a[172:175], v[56:59]
v_mfma_f32_16x16x32_bf16 v[40:43], a[228:231], a[168:171], v[40:43]
ds_read_b128 a[208:211], v5 offset:2048
v_mfma_f32_16x16x32_bf16 v[60:63], a[228:231], a[172:175], v[60:63]
v_mfma_f32_16x16x32_bf16 v[44:47], a[232:235], a[168:171], v[44:47]
ds_read_b128 a[212:215], v5 offset:3072
v_mfma_f32_16x16x32_bf16 v[64:67], a[232:235], a[172:175], v[64:67]
v_mfma_f32_16x16x32_bf16 v[48:51], a[236:239], a[168:171], v[48:51]
ds_read_b128 a[216:219], v5 offset:4096
v_mfma_f32_16x16x32_bf16 v[68:71], a[236:239], a[172:175], v[68:71]
s_waitcnt vmcnt(2)
s_barrier
s_waitcnt lgkmcnt(0)
v_mfma_f32_16x16x32_bf16 v[32:35], a[200:203], a[176:179], v[32:35]
ds_read_b128 a[220:223], v5 offset:10240
v_mfma_f32_16x16x32_bf16 v[52:55], a[200:203], a[180:183], v[52:55]
v_mfma_f32_16x16x32_bf16 v[36:39], a[204:207], a[176:179], v[36:39]
ds_read_b128 a[224:227], v5 offset:11264
v_mfma_f32_16x16x32_bf16 v[56:59], a[204:207], a[180:183], v[56:59]
v_mfma_f32_16x16x32_bf16 v[40:43], a[208:211], a[176:179], v[40:43]
ds_read_b128 a[228:231], v5 offset:12288
v_mfma_f32_16x16x32_bf16 v[60:63], a[208:211], a[180:183], v[60:63]
v_mfma_f32_16x16x32_bf16 v[44:47], a[212:215], a[176:179], v[44:47]
ds_read_b128 a[232:235], v5 offset:13312
v_mfma_f32_16x16x32_bf16 v[64:67], a[212:215], a[180:183], v[64:67]
v_mfma_f32_16x16x32_bf16 v[48:51], a[216:219], a[176:179], v[48:51]
ds_read_b128 a[236:239], v5 offset:14336
v_mfma_f32_16x16x32_bf16 v[68:71], a[216:219], a[180:183], v[68:71]
s_waitcnt vmcnt(0) lgkmcnt(0)
v_mfma_f32_16x16x32_bf16 v[32:35], a[220:223], a[184:187], v[32:35]
v_mfma_f32_16x16x32_bf16 v[52:55], a[220:223], a[188:191], v[52:55]
v_mfma_f32_16x16x32_bf16 v[36:39], a[224:227], a[184:187], v[36:39]
v_mfma_f32_16x16x32_bf16 v[56:59], a[224:227], a[188:191], v[56:59]
v_mfma_f32_16x16x32_bf16 v[40:43], a[228:231], a[184:187], v[40:43]
v_mfma_f32_16x16x32_bf16 v[60:63], a[228:231], a[188:191], v[60:63]
v_mfma_f32_16x16x32_bf16 v[44:47], a[232:235], a[184:187], v[44:47]
v_mfma_f32_16x16x32_bf16 v[64:67], a[232:235], a[188:191], v[64:67]
v_mfma_f32_16x16x32_bf16 v[48:51], a[236:239], a[184:187], v[48:51]
v_mfma_f32_16x16x32_bf16 v[68:71], a[236:239], a[188:191], v[68:71]
s_barrier
ds_write_b128 v8, v[52:55] offset:0
ds_write_b128 v8, v[56:59] offset:1024
s_nop 0
ds_write_b128 v8, v[60:63] offset:2048
s_nop 0
ds_write_b128 v8, v[64:67] offset:3072
s_nop 0
ds_write_b128 v8, v[68:71] offset:4096
s_waitcnt lgkmcnt(0)
s_barrier
ds_read_b128 v[52:55], v9 offset:0
ds_read_b128 v[56:59], v9 offset:1024
ds_read_b128 v[60:63], v9 offset:2048
ds_read_b128 v[64:67], v9 offset:3072
ds_read_b128 v[68:71], v9 offset:4096
s_waitcnt lgkmcnt(4)
v_pk_add_f32 v[32:33], v[32:33], v[52:53]
v_pk_add_f32 v[34:35], v[34:35], v[54:55]
s_waitcnt lgkmcnt(3)
v_pk_add_f32 v[36:37], v[36:37], v[56:57]
v_pk_add_f32 v[38:39], v[38:39], v[58:59]
s_waitcnt lgkmcnt(2)
v_pk_add_f32 v[40:41], v[40:41], v[60:61]
v_pk_add_f32 v[42:43], v[42:43], v[62:63]
s_waitcnt lgkmcnt(1)
v_pk_add_f32 v[44:45], v[44:45], v[64:65]
v_pk_add_f32 v[46:47], v[46:47], v[66:67]
s_waitcnt lgkmcnt(0)
v_pk_add_f32 v[48:49], v[48:49], v[68:69]
v_pk_add_f32 v[50:51], v[50:51], v[70:71]
v_lshlrev_b32 v10, 16, v240
v_and_b32 v11, 0xffff0000, v240
v_pk_add_f32 v[32:33], v[32:33], v[10:11]
v_cvt_pk_bf16_f32 v72, v32, v33
v_lshlrev_b32 v12, 16, v241
v_and_b32 v13, 0xffff0000, v241
v_pk_add_f32 v[34:35], v[34:35], v[12:13]
v_cvt_pk_bf16_f32 v73, v34, v35
v_lshlrev_b32 v10, 16, v242
v_and_b32 v11, 0xffff0000, v242
v_pk_add_f32 v[36:37], v[36:37], v[10:11]
v_cvt_pk_bf16_f32 v74, v36, v37
v_lshlrev_b32 v12, 16, v243
v_and_b32 v13, 0xffff0000, v243
v_pk_add_f32 v[38:39], v[38:39], v[12:13]
v_cvt_pk_bf16_f32 v75, v38, v39
v_lshlrev_b32 v10, 16, v244
v_and_b32 v11, 0xffff0000, v244
v_pk_add_f32 v[40:41], v[40:41], v[10:11]
v_cvt_pk_bf16_f32 v76, v40, v41
v_lshlrev_b32 v12, 16, v245
v_and_b32 v13, 0xffff0000, v245
v_pk_add_f32 v[42:43], v[42:43], v[12:13]
v_cvt_pk_bf16_f32 v77, v42, v43
v_lshlrev_b32 v10, 16, v246
v_and_b32 v11, 0xffff0000, v246
v_pk_add_f32 v[44:45], v[44:45], v[10:11]
v_cvt_pk_bf16_f32 v78, v44, v45
v_lshlrev_b32 v12, 16, v247
v_and_b32 v13, 0xffff0000, v247
v_pk_add_f32 v[46:47], v[46:47], v[12:13]
v_cvt_pk_bf16_f32 v79, v46, v47
v_lshlrev_b32 v10, 16, v248
v_and_b32 v11, 0xffff0000, v248
v_pk_add_f32 v[48:49], v[48:49], v[10:11]
v_cvt_pk_bf16_f32 v80, v48, v49
v_lshlrev_b32 v12, 16, v249
v_and_b32 v13, 0xffff0000, v249
v_pk_add_f32 v[50:51], v[50:51], v[12:13]
v_cvt_pk_bf16_f32 v81, v50, v51
buffer_store_dwordx2 v[72:73], v250, s[12:15], 0 offen offset:0
buffer_store_dwordx2 v[74:75], v250, s[12:15], 0 offen offset:32
buffer_store_dwordx2 v[76:77], v250, s[12:15], 0 offen offset:64
buffer_store_dwordx2 v[78:79], v250, s[12:15], 0 offen offset:96
buffer_store_dwordx2 v[80:81], v250, s[12:15], 0 offen offset:128
L_done:
s_endpgm
.fill 1757, 4, 0xbf810000
.section .rodata,"a"
.p2align 6
.amdhsa_kernel sequential_preLN__sliding_local_dilated__glu_gated_glu__prompt_kernel
  .amdhsa_next_free_vgpr 512
  .amdhsa_next_free_sgpr 102
  .amdhsa_accum_offset 256
  .amdhsa_group_segment_fixed_size 0
  .amdhsa_kernarg_size 80
  .amdhsa_user_sgpr_count 2
  .amdhsa_user_sgpr_kernarg_segment_ptr 1
  .amdhsa_system_sgpr_workgroup_id_x 1
.end_amdhsa_kernel
```
